```python
import torch

def _softmax(x, axis=-1):
    return torch.softmax(x, dim=axis)
def _gelu(x):
    return torch.nn.functional.gelu(x, approximate="tanh")
def _silu(x):
    return torch.nn.functional.silu(x)
def _sigmoid(x):
    return torch.sigmoid(x)
def _layernorm(x, axis=-1, eps=1e-5):
    m = x.mean(dim=axis, keepdim=True)
    v = x.var(dim=axis, keepdim=True, unbiased=False)
    return (x - m) / torch.sqrt(v + eps)
def _scatter_add(tgt, idx, src, axis=0):
    return tgt.clone().index_add_(axis, idx, src)
def _segment_sum(src, seg, n):
    out = torch.zeros((n,) + src.shape[1:], dtype=src.dtype)
    return out.index_add_(0, seg, src)
def _pad(x, pw):
    flat = tuple(v for pair in reversed(pw) for v in pair)
    return torch.nn.functional.pad(x, flat)

kernel_name = 'parallel_sum__linear_attn_block__dense_activation_gelu__prompt'

def setup_inputs():

    _w = (lambda a: (lambda t: t.to(torch.bfloat16) if t.is_floating_point() else t)(torch.as_tensor(a)))
    def _A_setup():
        B, S, D = 1, 2048, 640
        return {
            "x": _w((lambda *s: torch.randn(*s, dtype=torch.bfloat16) * 0.05)(B, S, D)),
            "wqkv": _w((lambda *s: torch.randn(*s, dtype=torch.bfloat16) * 0.05)(D, 3 * D)),
            "wo": _w((lambda *s: torch.randn(*s, dtype=torch.bfloat16) * 0.05)(D, D)),
        }
    _A_in = _A_setup()

    def _B_setup():
        B, S, D, F = 1, 2048, 640, 1536
        return {
            "x": _w((lambda *s: torch.randn(*s, dtype=torch.bfloat16) * 0.05)(B, S, D)),
            "w1": _w((lambda *s: torch.randn(*s, dtype=torch.bfloat16) * 0.4)(D, F) * (D ** -0.5)),
            "b1": _w((lambda *s: torch.randn(*s, dtype=torch.bfloat16) * 12.8)(F) * 0.01),
            "w2": _w((lambda *s: torch.randn(*s, dtype=torch.bfloat16) * 0.1)(F, D) * (F ** -0.5)),
            "b2": _w((lambda *s: torch.randn(*s, dtype=torch.bfloat16) * 1.6)(D) * 0.01),
        }
    _B_in = _B_setup()

    return {
        "A_x": _A_in["x"],
        "A_wqkv": _A_in["wqkv"],
        "A_wo": _A_in["wo"],
        "B_x": _B_in["x"],
        "B_w1": _B_in["w1"],
        "B_b1": _B_in["b1"],
        "B_w2": _B_in["w2"],
        "B_b2": _B_in["b2"],
    }

def reference(A_x, A_wqkv, A_wo, B_x, B_w1, B_b1, B_w2, B_b2):
    def _A_ref(x, wqkv, wo):
        B, S, D = x.shape
        H = 32; Dh = D // H
        qkv = (lambda x, *d: x.permute(*d))((x @ wqkv).reshape(B, S, 3, H, Dh), 2, 0, 3, 1, 4)
        q, k, v = qkv[0], qkv[1], qkv[2]
        phi = lambda t: torch.where(t > 0, t + 1, torch.exp(t)) + 1e-6
        pq, pk = phi(q), phi(k)
        kv = torch.einsum("bhsd,bhse->bhde", pk, v)
        z = torch.einsum("bhsd->bhd", pk)
        num = torch.einsum("bhqd,bhde->bhqe", pq, kv)
        den = torch.einsum("bhqd,bhd->bhq", pq, z)[..., None] + 1e-6
        o = num / den
        return (lambda x, *d: x.permute(*d))(o, 0, 2, 1, 3).reshape(B, S, D) @ wo

    def _B_ref(x, w1, b1, w2, b2):
        h = torch.einsum("bsd,df->bsf", x, w1) + b1
        h = _gelu(h)
        return torch.einsum("bsf,fd->bsd", h, w2) + b2

    x = A_x
    xn = _layernorm(x, axis=-1)
    return x + _A_ref(xn, A_wqkv, A_wo) + _B_ref(xn, B_w1, B_b1, B_w2, B_b2)
```

```asm
; @launch grid=(256,1,1) block=(512,1,1) lds=163840
.amdgcn_target "amdgcn-amd-amdhsa--gfx950"
.text
.globl parallel_sum__linear_attn_block__dense_activation_gelu__prompt_kernel
.p2align 8
.type parallel_sum__linear_attn_block__dense_activation_gelu__prompt_kernel,@function
parallel_sum__linear_attn_block__dense_activation_gelu__prompt_kernel:
  s_cmp_ge_u32 s2, 256
  s_cbranch_scc1 L_end
  s_load_dwordx16 s[36:51], s[0:1], 0
  s_load_dwordx4 s[52:55], s[0:1], 64
  s_load_dwordx2 s[56:57], s[0:1], 80
  v_lshrrev_b32 v1, 6, v0
  v_and_b32 v0, 63, v0
  v_readfirstlane_b32 s61, v1
  s_getpc_b64 s[78:79]
L_pc0:
  s_and_b32 s3, s2, 0xf8
  s_add_u32 s3, s3, s61
  s_lshl_b32 s3, s3, 7
  s_min_u32 s3, s3, L_table-L_pc0-64
  s_load_dword s80, s[78:79], s3
  s_add_u32 s3, s3, 64
  s_load_dword s80, s[78:79], s3
  s_bfe_u32 s60, s2, 0x10006
  s_and_b32 s3, s2, 7
  s_lshl_b32 s3, s3, 1
  s_bfe_u32 s58, s2, 0x10003
  s_add_u32 s58, s58, s3
  s_bfe_u32 s3, s2, 0x20004
  s_lshr_b32 s59, s2, 7
  s_lshl_b32 s59, s59, 2
  s_add_u32 s59, s59, s3
  s_and_b32 s3, s2, 7
  s_lshl_b32 s3, s3, 2
  s_bfe_u32 s81, s2, 0x20003
  s_add_u32 s81, s81, s3
  s_lshr_b32 s82, s2, 5
  s_cmp_lt_u32 s61, 4
  s_cbranch_scc1 L_compute
  s_sub_u32 s63, s61, 4
  v_lshrrev_b32 v2, 3, v0
  v_lshrrev_b32 v3, 4, v0
  v_and_b32 v4, 7, v0
  v_xor_b32 v5, v4, v3
  v_lshlrev_b32 v5, 4, v5
  s_lshl_b32 s3, s58, 7
  s_lshl_b32 s65, s63, 5
  s_add_u32 s3, s3, s65
  s_mul_i32 s3, s3, 1280
  v_mul_u32_u24 v6, 1280, v2
  v_add3_u32 v10, v6, v5, s3
  v_xor_b32 v11, 64, v10
  v_add_u32 v11, 10240, v11
  v_add_u32 v12, 20480, v10
  v_add_u32 v13, 20480, v11
  s_lshl_b32 s68, s63, 12
  s_xor_b32 s3, s58, s59
  s_and_b32 s3, s3, 1
  s_lshl_b32 s65, s60, 1
  s_add_u32 s3, s3, s65
  s_mov_b32 s76, 0x76543210
  s_mov_b32 s77, 0x98
  s_cmp_eq_u32 s3, 1
  s_cselect_b32 s76, 0x67452301, s76
  s_cselect_b32 s77, 0x89, s77
  s_cmp_eq_u32 s3, 2
  s_cselect_b32 s76, 0x76543210, s76
  s_cselect_b32 s77, 0x98, s77
  s_cmp_eq_u32 s3, 3
  s_cselect_b32 s76, 0x67452301, s76
  s_cselect_b32 s77, 0x89, s77
  s_and_b32 s3, s2, 7
  s_sub_u32 s65, s3, 5
  s_min_u32 s3, s3, s65
  s_lshl_b32 s64, s3, 1
  s_and_b32 s74, s76, 15
  s_add_u32 s74, s74, s64
  s_sub_u32 s3, s74, 10
  s_min_u32 s74, s74, s3
  s_lshl_b32 s73, s74, 7
  s_mul_i32 s75, s74, 196608
  s_mov_b32 s6, 0x280000
  s_mov_b32 s7, 0x20000
  s_waitcnt lgkmcnt(0)
  s_mov_b32 s4, s36
  s_mov_b32 s5, s37
  s_add_u32 m0, s68, 0
  s_nop 0
  buffer_load_dwordx4 v10, s[4:7], s73 offen lds
  s_add_u32 m0, s68, 1024
  s_nop 0
  buffer_load_dwordx4 v11, s[4:7], s73 offen lds
  s_add_u32 m0, s68, 2048
  s_nop 0
  buffer_load_dwordx4 v12, s[4:7], s73 offen lds
  s_add_u32 m0, s68, 3072
  s_nop 0
  buffer_load_dwordx4 v13, s[4:7], s73 offen lds
  v_and_b32 v6, 3, v2
  v_lshrrev_b32 v7, 2, v2
  v_lshl_add_u32 v6, v7, 3, v6
  v_mul_u32_u24 v6, 3072, v6
  v_and_b32 v7, 6, v2
  v_xor_b32 v7, v4, v7
  v_lshl_add_u32 v6, v7, 4, v6
  s_mul_i32 s65, s59, 384
  s_lshl_b32 s3, s60, 7
  s_add_u32 s65, s65, s3
  s_and_b32 s66, s63, 1
  s_lshr_b32 s3, s63, 1
  s_lshl_b32 s3, s3, 3
  s_add_u32 s3, s3, s66
  s_mul_i32 s3, s3, 12288
  s_add_u32 s3, s3, s65
  v_add_u32 v19, s3, v6
  v_add_u32 v20, 49152, v19
  s_movk_i32 s71, 26624
  s_cmp_eq_u32 s60, 0
  s_cselect_b32 s71, 36992, s71
  s_lshl_b32 s3, s63, 11
  s_add_u32 s71, s71, s3
  s_mov_b32 s12, s44
  s_mov_b32 s13, s45
  s_mov_b32 s14, 0x1e0000
  s_mov_b32 s15, 0x20000
  s_add_u32 m0, s71, 0
  s_nop 0
  buffer_load_dwordx4 v19, s[12:15], s75 offen lds
  s_add_u32 m0, s71, 1024
  s_nop 0
  buffer_load_dwordx4 v20, s[12:15], s75 offen lds
  s_lshr_b32 s3, s63, 1
  s_and_b32 s70, s3, s60
  s_cbranch_scc1 L_phmode
  s_mov_b32 s72, 245760
  s_lshr_b32 s3, s63, 1
  s_add_u32 s3, s3, 1
  s_cmp_eq_u32 s60, 0
  s_cselect_b32 s3, s3, 0
  s_mul_i32 s65, s3, 1280
  s_mul_i32 s67, s59, 160
  s_add_u32 s65, s65, s67
  s_mul_i32 s67, s66, 122880
  s_add_u32 s65, s65, s67
  s_movk_i32 s69, 16384
  s_cmp_eq_u32 s3, 2
  s_cselect_b32 s69, 26640, s69
  s_mul_i32 s67, s66, 5120
  s_add_u32 s69, s69, s67
  v_mul_u32_u24 v7, 6554, v0
  v_lshl_add_u32 v5, v0, 4, s65
  s_movk_i32 s3, 3680
  s_movk_i32 s67, 3840
  v_add_u32 v8, 0, v7
  v_lshrrev_b32 v8, 16, v8
  v_and_b32 v9, 12, v8
  v_add_u32 v14, 0x0, v5
  v_mad_u32_u24 v14, v8, s3, v14
  v_mad_u32_u24 v14, v9, s67, v14
  v_add_u32 v8, 419456, v7
  v_lshrrev_b32 v8, 16, v8
  v_and_b32 v9, 12, v8
  v_add_u32 v15, 0x400, v5
  v_mad_u32_u24 v15, v8, s3, v15
  v_mad_u32_u24 v15, v9, s67, v15
  v_add_u32 v8, 838912, v7
  v_lshrrev_b32 v8, 16, v8
  v_and_b32 v9, 12, v8
  v_add_u32 v16, 0x800, v5
  v_mad_u32_u24 v16, v8, s3, v16
  v_mad_u32_u24 v16, v9, s67, v16
  v_lshrrev_b32 v8, 4, v8
  v_mul_u32_u24 v8, 46080, v8
  v_sub_u32 v16, v16, v8
  v_add_u32 v8, 1258368, v7
  v_lshrrev_b32 v8, 16, v8
  v_and_b32 v9, 12, v8
  v_add_u32 v17, 0xffff5800, v5
  v_mad_u32_u24 v17, v8, s3, v17
  v_mad_u32_u24 v17, v9, s67, v17
  v_add_u32 v8, 1677824, v7
  v_lshrrev_b32 v8, 16, v8
  v_and_b32 v9, 12, v8
  v_add_u32 v18, 0xffff5c00, v5
  v_mad_u32_u24 v18, v8, s3, v18
  v_mad_u32_u24 v18, v9, s67, v18
  s_mov_b32 s20, s38
  s_mov_b32 s21, s39
  s_mov_b32 s22, 0x258000
  s_mov_b32 s23, 0x20000
  s_branch L_pdone
L_phmode:
  s_mov_b32 s72, 196608
  s_mul_i32 s3, s66, 98304
  s_add_u32 s3, s3, s65
  s_add_u32 s3, s3, 128
  v_add_u32 v14, s3, v6
  v_add_u32 v15, 49152, v14
  v_add_u32 v16, 12288, v14
  v_add_u32 v17, 61440, v14
  v_mov_b32 v18, 0x7f000000
  s_lshl_b32 s3, s66, 12
  s_add_u32 s69, s3, 34816
  s_mov_b32 s20, s44
  s_mov_b32 s21, s45
  s_mov_b32 s22, 0x1e0000
  s_mov_b32 s23, 0x20000
L_pdone:
  s_mul_i32 s74, s74, s72
  s_add_u32 m0, s69, 0
  s_nop 0
  buffer_load_dwordx4 v14, s[20:23], s74 offen lds
  s_add_u32 m0, s69, 1024
  s_nop 0
  buffer_load_dwordx4 v15, s[20:23], s74 offen lds
  s_add_u32 m0, s69, 2048
  s_nop 0
  buffer_load_dwordx4 v16, s[20:23], s74 offen lds
  s_add_u32 m0, s69, 3072
  s_nop 0
  buffer_load_dwordx4 v17, s[20:23], s74 offen lds
  s_cmp_lg_u32 s70, 0
  s_cbranch_scc1 Lnop4_1
  s_add_u32 m0, s69, 4096
  s_nop 0
  buffer_load_dwordx4 v18, s[20:23], s74 offen lds
Lnop4_1:
  s_lshr_b64 s[76:77], s[76:77], 4
  s_and_b32 s3, s76, 15
  s_add_u32 s3, s3, s64
  s_sub_u32 s73, s3, 10
  s_min_u32 s3, s3, s73
  s_lshl_b32 s73, s3, 7
  s_mul_i32 s74, s3, s72
  s_mul_i32 s75, s3, 196608
  s_mov_b32 s16, s56
  s_mov_b32 s17, s57
  s_mov_b32 s18, 0x1000000
  s_mov_b32 s19, 0x20000
  s_getpc_b64 s[46:47]
L_pc1:
  s_add_u32 s46, s46, L_table-L_pc1
  s_addc_u32 s47, s47, 0
  v_lshlrev_b32 v1, 4, v0
  s_lshl_b32 s3, s63, 10
  v_add_u32 v254, s3, v1
  s_lshl_b32 s3, s60, 12
  v_add_u32 v5, s3, v254
  v_lshrrev_b32 v21, 1, v5
  v_mov_b32 v22, 160320
  s_getreg_b32 s54, hwreg(HW_REG_XCC_ID, 0, 4)
  s_and_b32 s3, s2, 7
  s_lshl_b32 s3, s3, 5
  s_lshr_b32 s65, s2, 3
  s_add_u32 s3, s3, s65
  s_lshl_b32 s3, s3, 2
  s_add_u32 s3, s3, 0xd11000
  v_mov_b32 v23, s3
  s_mov_b32 s8, s40
  s_mov_b32 s9, s41
  s_mov_b32 s10, 0x0
  s_mov_b32 s11, 0x20000
  s_mov_b32 s28, s40
  s_mov_b32 s29, s41
  s_mov_b32 s30, 0x0
  s_mov_b32 s31, 0x20000
  v_mov_b32 v24, 0
  v_mov_b32 v25, 0
  s_mov_b32 s85, 45184
  s_mov_b32 s84, 1
  s_branch L_kvi
L_kvl:
  s_lshl_b32 s3, s60, 4
  s_add_u32 s27, s3, s84
  s_cmp_lg_u32 s27, 18
  s_cbranch_scc1 L_nojs
  s_sub_u32 s3, 3, s63
  s_lshl_b32 s24, s3, 7
  s_lshl_b32 s3, s58, 3
  s_add_u32 s24, s24, s3
  s_add_u32 s24, s24, s59
  v_and_b32 v7, 6, v2
  v_xor_b32 v7, v4, v7
  v_lshlrev_b32 v7, 4, v7
  v_lshrrev_b32 v8, 5, v0
  v_and_b32 v9, 3, v2
  s_mul_i32 s3, s24, 6554
  s_lshr_b32 s25, s3, 16
  s_mul_i32 s3, s25, 10
  s_sub_u32 s26, s24, s3
  s_cmp_lt_u32 s25, 48
  s_cselect_b32 s8, s48, s40
  s_cselect_b32 s9, s49, s41
  s_mov_b32 s10, 819200
  s_cselect_b32 s10, 1966080, s10
  s_lshl_b32 s32, s25, 5
  s_mul_i32 s3, s25, 40
  s_sub_u32 s3, s3, 1920
  s_cmp_lt_u32 s25, 48
  s_cselect_b32 s32, s32, s3
  s_mul_i32 s3, s25, 160
  s_sub_u32 s3, s3, 10208
  s_cmp_lt_u32 s25, 64
  s_cselect_b32 s32, s32, s3
  s_cselect_b32 s33, 4, 40
  s_cselect_b32 s34, 16, 4
  v_mad_u32_u24 v24, s33, v8, v9
  v_mul_u32_u24 v24, 1280, v24
  v_add_u32 v24, v24, v7
  s_mul_i32 s32, s32, 1280
  s_lshl_b32 s3, s26, 7
  s_add_u32 s32, s32, s3
  s_mul_i32 s33, s33, 2560
  s_mul_i32 s34, s34, 1280
  s_lshl_b32 s52, s24, 12
  s_add_u32 s52, s52, 0x900000
  s_add_u32 s24, s24, 512
  s_mul_i32 s3, s24, 6554
  s_lshr_b32 s25, s3, 16
  s_mul_i32 s3, s25, 10
  s_sub_u32 s26, s24, s3
  s_cmp_lt_u32 s25, 48
  s_cselect_b32 s28, s48, s40
  s_cselect_b32 s29, s49, s41
  s_mov_b32 s30, 819200
  s_cselect_b32 s30, 1966080, s30
  s_lshl_b32 s35, s25, 5
  s_mul_i32 s3, s25, 40
  s_sub_u32 s3, s3, 1920
  s_cmp_lt_u32 s25, 48
  s_cselect_b32 s35, s35, s3
  s_mul_i32 s3, s25, 160
  s_sub_u32 s3, s3, 10208
  s_cmp_lt_u32 s25, 64
  s_cselect_b32 s35, s35, s3
  s_cselect_b32 s50, 4, 40
  s_cselect_b32 s51, 16, 4
  v_mad_u32_u24 v25, s50, v8, v9
  v_mul_u32_u24 v25, 1280, v25
  v_add_u32 v25, v25, v7
  s_mul_i32 s35, s35, 1280
  s_lshl_b32 s3, s26, 7
  s_add_u32 s35, s35, s3
  s_mul_i32 s50, s50, 2560
  s_mul_i32 s51, s51, 1280
  s_lshl_b32 s53, s24, 12
  s_add_u32 s53, s53, 0x900000
  v_lshrrev_b32 v5, 2, v0
  v_and_b32 v6, 3, v0
  v_lshlrev_b32 v7, 7, v5
  v_lshl_add_u32 v7, v6, 3, v7
  v_bfe_u32 v5, v0, 3, 2
  v_lshl_add_u32 v7, v5, 5, v7
  s_add_u32 s3, s68, 135552
  v_add_u32 v26, s3, v7
  v_xor_b32 v27, 32, v26
  v_xor_b32 v28, 64, v26
  v_xor_b32 v29, 0x60, v26
L_nojs:
  s_waitcnt vmcnt(10)
  s_barrier
  s_sub_u32 s3, s27, 18
  s_cmp_gt_u32 s3, 2
  s_cbranch_scc1 L_nojob
  s_cmp_lg_u32 s3, 0
  s_cbranch_scc1 L_j1
  s_add_u32 m0, s68, 135552
  s_add_u32 s3, s32, s33
  buffer_load_dwordx4 v24, s[8:11], s32 offen lds
  s_add_u32 m0, m0, 0x400
  s_add_u32 s32, s32, s34
  buffer_load_dwordx4 v24, s[8:11], s3 offen lds
  s_add_u32 m0, m0, 0x400
  s_add_u32 s3, s32, s33
  buffer_load_dwordx4 v24, s[8:11], s32 offen lds
  s_add_u32 m0, m0, 0x400
  s_nop 0
  buffer_load_dwordx4 v24, s[8:11], s3 offen lds
  s_cmp_ge_u32 s24, 680
  s_cbranch_scc1 L_kvi
  s_add_u32 m0, s68, 143744
  s_add_u32 s3, s35, s50
  buffer_load_dwordx4 v25, s[28:31], s35 offen lds
  s_add_u32 m0, m0, 0x400
  s_add_u32 s35, s35, s51
  buffer_load_dwordx4 v25, s[28:31], s3 offen lds
  s_add_u32 m0, m0, 0x400
  s_add_u32 s3, s35, s50
  buffer_load_dwordx4 v25, s[28:31], s35 offen lds
  s_add_u32 m0, m0, 0x400
  s_nop 0
  buffer_load_dwordx4 v25, s[28:31], s3 offen lds
  s_branch L_kvi
L_j1:
  s_cmp_lg_u32 s3, 1
  s_cbranch_scc1 L_j2
  ds_read_b64_tr_b16 v[32:33], v26 offset:0
  ds_read_b64_tr_b16 v[34:35], v26 offset:2048
  ds_read_b64_tr_b16 v[36:37], v27 offset:0
  ds_read_b64_tr_b16 v[38:39], v27 offset:2048
  ds_read_b64_tr_b16 v[40:41], v28 offset:0
  ds_read_b64_tr_b16 v[42:43], v28 offset:2048
  ds_read_b64_tr_b16 v[44:45], v29 offset:0
  ds_read_b64_tr_b16 v[46:47], v29 offset:2048
  ds_read_b64_tr_b16 v[48:49], v26 offset:8192
  ds_read_b64_tr_b16 v[50:51], v26 offset:10240
  ds_read_b64_tr_b16 v[52:53], v27 offset:8192
  ds_read_b64_tr_b16 v[54:55], v27 offset:10240
  ds_read_b64_tr_b16 v[56:57], v28 offset:8192
  ds_read_b64_tr_b16 v[58:59], v28 offset:10240
  ds_read_b64_tr_b16 v[60:61], v29 offset:8192
  ds_read_b64_tr_b16 v[62:63], v29 offset:10240
  s_branch L_kvi
L_j2:
  s_waitcnt lgkmcnt(0)
  buffer_store_dwordx4 v[32:35], v1, s[16:19], s52 offen offset:0 sc1
  buffer_store_dwordx4 v[36:39], v1, s[16:19], s52 offen offset:1024 sc1
  buffer_store_dwordx4 v[40:43], v1, s[16:19], s52 offen offset:2048 sc1
  buffer_store_dwordx4 v[44:47], v1, s[16:19], s52 offen offset:3072 sc1
  s_cmp_ge_u32 s24, 680
  s_cbranch_scc1 L_kvi
  buffer_store_dwordx4 v[48:51], v1, s[16:19], s53 offen offset:0 sc1
  buffer_store_dwordx4 v[52:55], v1, s[16:19], s53 offen offset:1024 sc1
  buffer_store_dwordx4 v[56:59], v1, s[16:19], s53 offen offset:2048 sc1
  buffer_store_dwordx4 v[60:63], v1, s[16:19], s53 offen offset:3072 sc1
  s_branch L_kvi
L_nojob:
  s_lshl_b32 s3, s84, 2
  s_add_u32 s3, s3, s63
  s_cmp_lg_u32 s3, 23
  s_cbranch_scc1 L_kvi
  ds_read_b32 v6, v22
  s_mov_b64 exec, 1
  s_waitcnt lgkmcnt(0)
  v_xor_b32 v6, s54, v6
  buffer_store_dword v6, v23, s[16:19], 0 offen sc1
  s_mov_b64 exec, -1
L_kvi:
  s_add_u32 m0, s68, s85
  s_nop 0
  buffer_load_dwordx4 v10, s[4:7], s73 offen lds
  s_add_u32 m0, m0, 0x400
  s_nop 0
  buffer_load_dwordx4 v11, s[4:7], s73 offen lds
  s_add_u32 m0, m0, 0x400
  s_nop 0
  buffer_load_dwordx4 v12, s[4:7], s73 offen lds
  s_add_u32 m0, m0, 0x400
  s_nop 0
  buffer_load_dwordx4 v13, s[4:7], s73 offen lds
  s_add_u32 m0, s71, s85
  s_nop 0
  buffer_load_dwordx4 v19, s[12:15], s75 offen lds
  s_add_u32 m0, m0, 0x400
  s_nop 0
  buffer_load_dwordx4 v20, s[12:15], s75 offen lds
  s_add_u32 m0, s69, s85
  s_nop 0
  buffer_load_dwordx4 v14, s[20:23], s74 offen lds
  s_add_u32 m0, m0, 0x400
  s_nop 0
  buffer_load_dwordx4 v15, s[20:23], s74 offen lds
  s_add_u32 m0, m0, 0x400
  s_nop 0
  buffer_load_dwordx4 v16, s[20:23], s74 offen lds
  s_add_u32 m0, m0, 0x400
  s_nop 0
  buffer_load_dwordx4 v17, s[20:23], s74 offen lds
  s_cmp_lg_u32 s70, 0
  s_cbranch_scc1 Lnop4_2
  s_add_u32 m0, m0, 0x400
  s_nop 0
  buffer_load_dwordx4 v18, s[20:23], s74 offen lds
Lnop4_2:
  s_lshr_b64 s[76:77], s[76:77], 4
  s_and_b32 s3, s76, 15
  s_add_u32 s3, s3, s64
  s_sub_u32 s73, s3, 10
  s_min_u32 s3, s3, s73
  s_lshl_b32 s73, s3, 7
  s_mul_i32 s74, s3, s72
  s_mul_i32 s75, s3, 196608
  s_add_u32 s85, s85, 45184
  s_cmp_eq_u32 s85, 135552
  s_cselect_b32 s85, 0, s85
  s_add_u32 s84, s84, 1
  s_cmp_lt_u32 s84, 9
  s_cbranch_scc1 L_kvl
  s_setprio 3
  global_load_dwordx2 v[252:253], v21, s[46:47]
  v_mov_b32 v6, 160320
  ds_read_b32 v6, v6
  v_lshlrev_b32 v1, 4, v0
  v_add_u32 v2, 4096, v1
  s_mul_i32 s83, s63, 12
  s_lshl_b32 s84, s63, 2
  s_add_u32 s84, s84, 48
  s_add_u32 s85, s63, 64
  s_mul_i32 s3, s81, 68
  s_add_u32 s36, s3, s83
  s_lshl_b32 s36, s36, 12
  s_add_u32 s37, s3, s84
  s_lshl_b32 s37, s37, 12
  s_add_u32 s38, s3, s85
  s_lshl_b32 s38, s38, 12
  s_mul_i32 s3, s82, 5120
  s_add_u32 s3, s3, 0x900000
  s_mul_i32 s39, s83, 40960
  s_add_u32 s39, s39, s3
  s_mul_i32 s42, s84, 40960
  s_add_u32 s42, s42, s3
  s_mul_i32 s43, s85, 40960
  s_add_u32 s43, s43, s3
  s_xor_b32 s56, s60, 1
  s_lshl_b32 s3, s56, 12
  s_add_u32 s44, s36, s3
  s_mul_i32 s3, s56, 40960
  s_add_u32 s45, s39, s3
  s_sub_u32 s55, s39, s3
  s_add_u32 s55, s55, 40960
  v_and_b32 v29, 15, v0
  v_min_u32 v29, 13, v29
  v_lshlrev_b32 v29, 4, v29
  s_mul_i32 s3, s63, 224
  v_add_u32 v29, s3, v29
  v_lshrrev_b32 v30, 4, v0
  v_lshl_add_u32 v31, v30, 10, v29
  v_and_b32 v30, 0x7ff, v31
  v_add_u32 v29, 161792, v29
  s_lshl_b32 s3, s60, 3
  s_add_u32 s3, s3, s59
  s_mul_i32 s46, s3, 10240
  s_add_u32 s46, s46, 0xd20000
  v_add_u32 v255, 4096, v254
  v_cmp_gt_u32 vcc, 2624, v254
  v_mov_b32 v3, 0x7f000000
  s_mov_b64 s[78:79], vcc
  v_cndmask_b32 v255, v3, v255, vcc
  s_lshl_b32 s65, s63, 10
  s_lshl_b32 s3, s58, 11
  s_add_u32 s65, s65, s3
  s_add_u32 s65, s65, 0xcffc00
  s_cmp_eq_u32 s63, 3
  s_cselect_b32 s65, 0xd11000, s65
  s_cselect_b32 s66, -16, 0
  s_cselect_b32 s67, -16, -1
  s_waitcnt lgkmcnt(0)
  v_readfirstlane_b32 s62, v6
  s_waitcnt vmcnt(11)
  s_barrier
  s_cmp_eq_u32 s63, 0
  s_cbranch_scc1 L_ck1
  buffer_load_dwordx4 v[24:27], v1, s[16:19], s65 offen sc1
L_ck1:
  s_add_u32 m0, s68, 0
  s_nop 0
  buffer_load_dwordx4 v10, s[4:7], s73 offen lds
  s_lshr_b32 s40, s62, 0
  s_lshr_b32 s41, s62, 8
  s_lshr_b32 s48, s62, 16
  s_lshr_b32 s49, s62, 24
  s_add_u32 m0, s68, 1024
  s_nop 0
  buffer_load_dwordx4 v11, s[4:7], s73 offen lds
  v_mov_b32 v4, 0
  v_mov_b32 v5, 0
  v_mov_b32 v6, 0
  v_mov_b32 v7, 0
  v_add_u32 v8, 147456, v254
  v_add_u32 v9, 155648, v1
  s_add_u32 m0, s68, 2048
  s_nop 0
  buffer_load_dwordx4 v12, s[4:7], s73 offen lds
  ds_write_b128 v8, v[4:7]
  ds_write_b128 v8, v[4:7] offset:4096
  ds_write_b128 v9, v[4:7]
  s_add_u32 m0, s68, 3072
  s_nop 0
  buffer_load_dwordx4 v13, s[4:7], s73 offen lds
  s_add_u32 m0, s71, 0
  s_nop 0
  buffer_load_dwordx4 v19, s[12:15], s75 offen lds
  s_add_u32 m0, s71, 1024
  s_nop 0
  buffer_load_dwordx4 v20, s[12:15], s75 offen lds
  s_add_u32 m0, s69, 0
  s_nop 0
  buffer_load_dwordx4 v14, s[20:23], s74 offen lds
  s_add_u32 m0, s69, 1024
  s_nop 0
  buffer_load_dwordx4 v15, s[20:23], s74 offen lds
  s_add_u32 m0, s69, 2048
  s_nop 0
  buffer_load_dwordx4 v16, s[20:23], s74 offen lds
  s_add_u32 m0, s69, 3072
  s_nop 0
  buffer_load_dwordx4 v17, s[20:23], s74 offen lds
  s_cmp_lg_u32 s70, 0
  s_cbranch_scc1 Lnop4_3
  s_add_u32 m0, s69, 4096
  s_nop 0
  buffer_load_dwordx4 v18, s[20:23], s74 offen lds
Lnop4_3:
  s_mov_b32 s80, 200000
  s_waitcnt vmcnt(10)
  s_cmp_eq_u32 s63, 3
  s_cbranch_scc1 L_chk
  s_barrier
  s_cmp_eq_u32 s63, 0
  s_cbranch_scc1 L_chkok
L_chk:
  v_xor_b32 v32, s62, v24
  v_xor_b32 v33, s62, v25
  v_xor_b32 v34, s62, v26
  v_xor_b32 v35, s62, v27
  v_or_b32 v3, v32, v34
  v_or_b32 v4, v33, v35
  v_and_b32 v3, s66, v3
  v_and_b32 v4, s67, v4
  v_or_b32 v3, v3, v4
  v_cmp_ne_u32 vcc, 0, v3
  s_cbranch_vccz L_chkw
  s_sleep 8
  buffer_load_dwordx4 v[24:27], v1, s[16:19], s65 offen sc1
  s_waitcnt vmcnt(0)
  s_sub_u32 s80, s80, 1
  s_cbranch_scc0 L_chk
L_chkw:
  s_cmp_eq_u32 s63, 3
  s_cbranch_scc1 L_chk3
  s_lshl_b32 s3, s63, 8
  s_add_u32 s3, s3, 160512
  v_lshl_add_u32 v3, v0, 2, s3
  ds_write2st64_b32 v3, v24, v26 offset0:0 offset1:2
  s_branch L_chkok
L_chk3:
  s_getreg_b32 s3, hwreg(HW_REG_XCC_ID, 0, 4)
  v_xor_b32 v3, s3, v32
  v_bitop3_b32 v3, v3, v33, s3 bitop3:0xf6
  v_bitop3_b32 v3, v3, v34, s3 bitop3:0xf6
  v_bitop3_b32 v3, v3, v35, s3 bitop3:0xf6
  v_cmp_ne_u32 vcc, 0, v3
  s_and_b32 s3, s2, 7
  s_lshl_b32 s3, s3, 3
  s_lshr_b64 vcc, vcc, s3
  s_and_b32 s3, vcc_lo, 0xff
  s_cselect_b32 s3, 0, 1
  v_mov_b32 v3, 160384
  v_mov_b32 v4, s3
  ds_write_b32 v3, v4
  s_barrier
  s_branch L_chkok
L_chkok:
  s_add_u32 s3, s46, 0
  buffer_load_dwordx4 v[36:39], v31, s[16:19], s3 offen sc1
  s_add_u32 s3, s46, 4096
  buffer_load_dwordx4 v[40:43], v31, s[16:19], s3 offen sc1
  s_add_u32 s3, s46, 8192
  buffer_load_dwordx4 v[44:47], v30, s[16:19], s3 offen sc1
  s_add_u32 s3, s45, 81920
  buffer_load_dwordx4 v[84:87], v1, s[16:19], s3 offen offset:0 sc1
  buffer_load_dwordx4 v[88:91], v1, s[16:19], s3 offen offset:1024 sc1
  buffer_load_dwordx4 v[92:95], v1, s[16:19], s3 offen offset:2048 sc1
  buffer_load_dwordx4 v[96:99], v1, s[16:19], s3 offen offset:3072 sc1
  buffer_load_dwordx4 v[100:103], v2, s[16:19], s3 offen sc1
  s_add_u32 s3, s45, 163840
  buffer_load_dwordx4 v[104:107], v1, s[16:19], s3 offen offset:0 sc1
  buffer_load_dwordx4 v[108:111], v1, s[16:19], s3 offen offset:1024 sc1
  buffer_load_dwordx4 v[112:115], v1, s[16:19], s3 offen offset:2048 sc1
  buffer_load_dwordx4 v[116:119], v1, s[16:19], s3 offen offset:3072 sc1
  buffer_load_dwordx4 v[120:123], v2, s[16:19], s3 offen sc1
  s_add_u32 s3, s45, 327680
  buffer_load_dwordx4 v[124:127], v1, s[16:19], s3 offen offset:0 sc1
  buffer_load_dwordx4 v[128:131], v1, s[16:19], s3 offen offset:1024 sc1
  buffer_load_dwordx4 v[132:135], v1, s[16:19], s3 offen offset:2048 sc1
  buffer_load_dwordx4 v[136:139], v1, s[16:19], s3 offen offset:3072 sc1
  buffer_load_dwordx4 v[140:143], v2, s[16:19], s3 offen sc1
  s_waitcnt vmcnt(18) lgkmcnt(0)
  s_barrier
  v_mov_b32 v6, 160384
  ds_read_b32 v6, v6
  s_mov_b32 s80, 200000
  s_waitcnt vmcnt(15)
L_cchk:
  v_xor_b32 v3, s40, v36
  v_bitop3_b32 v3, v3, v37, s41 bitop3:0xf6
  v_bitop3_b32 v3, v3, v38, s48 bitop3:0xf6
  v_bitop3_b32 v3, v3, v39, s49 bitop3:0xf6
  v_bitop3_b32 v3, v3, v40, s40 bitop3:0xf6
  v_bitop3_b32 v3, v3, v41, s41 bitop3:0xf6
  v_bitop3_b32 v3, v3, v42, s48 bitop3:0xf6
  v_bitop3_b32 v3, v3, v43, s49 bitop3:0xf6
  v_bitop3_b32 v3, v3, v44, s40 bitop3:0xf6
  v_bitop3_b32 v3, v3, v45, s41 bitop3:0xf6
  v_bitop3_b32 v3, v3, v46, s48 bitop3:0xf6
  v_bitop3_b32 v3, v3, v47, s49 bitop3:0xf6
  v_and_b32 v3, 0xff, v3
  v_cmp_ne_u32 vcc, 0, v3
  s_cbranch_vccz L_cchkok
  s_sleep 8
  s_add_u32 s3, s46, 0
  buffer_load_dwordx4 v[36:39], v31, s[16:19], s3 offen sc1
  s_add_u32 s3, s46, 4096
  buffer_load_dwordx4 v[40:43], v31, s[16:19], s3 offen sc1
  s_add_u32 s3, s46, 8192
  buffer_load_dwordx4 v[44:47], v30, s[16:19], s3 offen sc1
  s_waitcnt vmcnt(0)
  s_sub_u32 s80, s80, 1
  s_cbranch_scc0 L_cchk
L_cchkok:
  v_add_f32 v36, v36, v40
  v_add_f32 v37, v37, v41
  v_add_f32 v38, v38, v42
  v_add_f32 v39, v39, v43
  s_mov_b32 exec_hi, 0
  v_add_f32 v36, v36, v44
  v_add_f32 v37, v37, v45
  v_add_f32 v38, v38, v46
  v_add_f32 v39, v39, v47
  s_mov_b64 exec, -1
  v_mov_b32 v40, v36
  v_mov_b32 v41, v37
  v_mov_b32 v42, v38
  v_mov_b32 v43, v39
  s_nop 1
  v_permlane16_swap_b32 v36, v40
  v_permlane16_swap_b32 v37, v41
  v_permlane16_swap_b32 v38, v42
  v_permlane16_swap_b32 v39, v43
  s_nop 0
  v_add_f32 v36, v36, v40
  v_add_f32 v37, v37, v41
  v_add_f32 v38, v38, v42
  v_add_f32 v39, v39, v43
  v_mov_b32 v40, v36
  v_mov_b32 v41, v37
  v_mov_b32 v42, v38
  v_mov_b32 v43, v39
  s_nop 1
  v_permlane32_swap_b32 v36, v40
  v_permlane32_swap_b32 v37, v41
  v_permlane32_swap_b32 v38, v42
  v_permlane32_swap_b32 v39, v43
  s_nop 0
  v_add_f32 v36, v36, v40
  v_add_f32 v37, v37, v41
  v_add_f32 v38, v38, v42
  v_add_f32 v39, v39, v43
  ds_write_b128 v29, v[36:39]
  s_add_u32 s3, s45, 409600
  buffer_load_dwordx4 v[144:147], v1, s[16:19], s3 offen offset:0 sc1
  buffer_load_dwordx4 v[148:151], v1, s[16:19], s3 offen offset:1024 sc1
  buffer_load_dwordx4 v[152:155], v1, s[16:19], s3 offen offset:2048 sc1
  buffer_load_dwordx4 v[156:159], v1, s[16:19], s3 offen offset:3072 sc1
  buffer_load_dwordx4 v[160:163], v2, s[16:19], s3 offen sc1
  s_add_u32 s3, s42, 0
  buffer_load_dwordx4 v[164:167], v1, s[16:19], s3 offen offset:0 sc1
  buffer_load_dwordx4 v[168:171], v1, s[16:19], s3 offen offset:1024 sc1
  buffer_load_dwordx4 v[172:175], v1, s[16:19], s3 offen offset:2048 sc1
  buffer_load_dwordx4 v[176:179], v1, s[16:19], s3 offen offset:3072 sc1
  buffer_load_dwordx4 v[180:183], v2, s[16:19], s3 offen sc1
  s_mul_i32 s75, s59, 6912
  s_add_u32 s75, s75, 0xd50000
  s_waitcnt lgkmcnt(0)
  v_readfirstlane_b32 s54, v6
  s_barrier
  s_setprio 0
  s_add_u32 s3, s55, 81920
  s_mul_i32 m0, s63, 30720
  s_add_u32 m0, m0, 0
  s_nop 0
  buffer_load_dwordx4 v1, s[16:19], s3 offen offset:0 sc1 lds
  buffer_load_dwordx4 v1, s[16:19], s3 offen offset:1024 sc1 lds
  buffer_load_dwordx4 v1, s[16:19], s3 offen offset:2048 sc1 lds
  buffer_load_dwordx4 v1, s[16:19], s3 offen offset:3072 sc1 lds
  s_add_u32 m0, m0, 4096
  s_nop 0
  buffer_load_dwordx4 v2, s[16:19], s3 offen sc1 lds
  s_add_u32 s3, s55, 163840
  s_mul_i32 m0, s63, 30720
  s_add_u32 m0, m0, 5120
  s_nop 0
  buffer_load_dwordx4 v1, s[16:19], s3 offen offset:0 sc1 lds
  buffer_load_dwordx4 v1, s[16:19], s3 offen offset:1024 sc1 lds
  buffer_load_dwordx4 v1, s[16:19], s3 offen offset:2048 sc1 lds
  buffer_load_dwordx4 v1, s[16:19], s3 offen offset:3072 sc1 lds
  s_add_u32 m0, m0, 4096
  s_nop 0
  buffer_load_dwordx4 v2, s[16:19], s3 offen sc1 lds
  s_add_u32 s3, s55, 327680
  s_mul_i32 m0, s63, 30720
  s_add_u32 m0, m0, 10240
  s_nop 0
  buffer_load_dwordx4 v1, s[16:19], s3 offen offset:0 sc1 lds
  buffer_load_dwordx4 v1, s[16:19], s3 offen offset:1024 sc1 lds
  buffer_load_dwordx4 v1, s[16:19], s3 offen offset:2048 sc1 lds
  buffer_load_dwordx4 v1, s[16:19], s3 offen offset:3072 sc1 lds
  s_add_u32 m0, m0, 4096
  s_nop 0
  buffer_load_dwordx4 v2, s[16:19], s3 offen sc1 lds
  s_add_u32 s3, s55, 409600
  s_mul_i32 m0, s63, 30720
  s_add_u32 m0, m0, 15360
  s_nop 0
  buffer_load_dwordx4 v1, s[16:19], s3 offen offset:0 sc1 lds
  buffer_load_dwordx4 v1, s[16:19], s3 offen offset:1024 sc1 lds
  buffer_load_dwordx4 v1, s[16:19], s3 offen offset:2048 sc1 lds
  buffer_load_dwordx4 v1, s[16:19], s3 offen offset:3072 sc1 lds
  s_add_u32 m0, m0, 4096
  s_nop 0
  buffer_load_dwordx4 v2, s[16:19], s3 offen sc1 lds
  s_add_u32 s3, s39, 0
  s_mul_i32 m0, s63, 30720
  s_add_u32 m0, m0, 20480
  s_nop 0
  buffer_load_dwordx4 v1, s[16:19], s3 offen offset:0 sc1 lds
  buffer_load_dwordx4 v1, s[16:19], s3 offen offset:1024 sc1 lds
  buffer_load_dwordx4 v1, s[16:19], s3 offen offset:2048 sc1 lds
  buffer_load_dwordx4 v1, s[16:19], s3 offen offset:3072 sc1 lds
  s_add_u32 m0, m0, 4096
  s_nop 0
  buffer_load_dwordx4 v2, s[16:19], s3 offen sc1 lds
  s_add_u32 s3, s39, 40960
  s_mul_i32 m0, s63, 30720
  s_add_u32 m0, m0, 25600
  s_nop 0
  buffer_load_dwordx4 v1, s[16:19], s3 offen offset:0 sc1 lds
  buffer_load_dwordx4 v1, s[16:19], s3 offen offset:1024 sc1 lds
  buffer_load_dwordx4 v1, s[16:19], s3 offen offset:2048 sc1 lds
  buffer_load_dwordx4 v1, s[16:19], s3 offen offset:3072 sc1 lds
  s_add_u32 m0, m0, 4096
  s_nop 0
  buffer_load_dwordx4 v2, s[16:19], s3 offen sc1 lds
  s_lshl_b32 s77, s81, 9
  s_add_u32 s77, s77, 0xd14000
  s_lshl_b32 s3, s83, 2
  s_add_u32 s76, s77, s3
  s_lshl_b32 s3, s84, 2
  s_add_u32 s77, s77, s3
  s_add_u32 s68, s37, 0
  s_add_u32 s69, s37, 4096
  s_add_u32 s70, s37, 8192
  s_add_u32 s71, s37, 12288
  s_add_u32 s3, s42, 40960
  buffer_load_dwordx4 v[184:187], v1, s[16:19], s3 offen offset:0 sc1
  buffer_load_dwordx4 v[188:191], v1, s[16:19], s3 offen offset:1024 sc1
  buffer_load_dwordx4 v[192:195], v1, s[16:19], s3 offen offset:2048 sc1
  buffer_load_dwordx4 v[196:199], v1, s[16:19], s3 offen offset:3072 sc1
  buffer_load_dwordx4 v[200:203], v2, s[16:19], s3 offen sc1
  s_add_u32 s3, s42, 81920
  buffer_load_dwordx4 v[204:207], v1, s[16:19], s3 offen offset:0 sc1
  buffer_load_dwordx4 v[208:211], v1, s[16:19], s3 offen offset:1024 sc1
  buffer_load_dwordx4 v[212:215], v1, s[16:19], s3 offen offset:2048 sc1
  buffer_load_dwordx4 v[216:219], v1, s[16:19], s3 offen offset:3072 sc1
  buffer_load_dwordx4 v[220:223], v2, s[16:19], s3 offen sc1
  s_cmp_lg_u32 s60, 0
  s_cbranch_scc1 L_lq1
  s_lshl_b32 s66, s59, 4
  s_mul_i32 s66, s66, 6912
  s_add_u32 s66, s66, 0xc00000
  s_mul_i32 s3, s58, 6912
  s_add_u32 s65, s66, s3
  v_mov_b32 v3, 0xff
  s_lshl_b32 s73, s58, 2
  s_add_u32 s73, s73, s63
  s_lshl_b32 s3, s73, 7
  s_add_u32 s66, s66, s3
  s_add_u32 s75, s75, s3
  s_add_u32 s67, s66, 55296
  s_cmp_eq_u32 s73, 52
  s_cselect_b32 s3, 3, 7
  v_and_b32 v21, s3, v0
  v_lshlrev_b32 v21, 4, v21
  v_lshrrev_b32 v20, 3, v0
  v_mul_u32_u24 v20, 6912, v20
  v_add_u32 v20, v20, v21
  s_setprio 2
  v_mov_b32 v4, 160260
  s_mov_b32 s80, 4000000
Llw_4:
  ds_read_b32 v5, v4
  s_waitcnt lgkmcnt(0)
  v_cmp_ne_u32 vcc, 4, v5
  s_cbranch_vccz Llw_4_d
  s_sleep 1
  s_sub_u32 s80, s80, 1
  s_cbranch_scc0 Llw_4
Llw_4_d:
  ds_read_b128 v[4:7], v252
  ds_read_b128 v[8:11], v252 offset:16384
  ds_read_b128 v[12:15], v253
  ds_read_b128 v[16:19], v253 offset:16384
  s_waitcnt lgkmcnt(2)
  v_add_f32 v4, v4, v8
  v_add_f32 v5, v5, v9
  v_add_f32 v6, v6, v10
  v_add_f32 v7, v7, v11
  v_bfi_b32 v4, v3, s40, v4
  v_bfi_b32 v5, v3, s41, v5
  v_bfi_b32 v6, v3, s48, v6
  v_bfi_b32 v7, v3, s49, v7
  buffer_store_dwordx4 v[4:7], v254, s[16:19], s65 offen sc1
  s_waitcnt lgkmcnt(0)
  v_add_f32 v12, v12, v16
  v_add_f32 v13, v13, v17
  v_add_f32 v14, v14, v18
  v_add_f32 v15, v15, v19
  v_bfi_b32 v12, v3, s40, v12
  v_bfi_b32 v13, v3, s41, v13
  v_bfi_b32 v14, v3, s48, v14
  v_bfi_b32 v15, v3, s49, v15
  buffer_store_dwordx4 v[12:15], v255, s[16:19], s65 offen sc1
  s_waitcnt vmcnt(2)
  s_lshl_b32 s3, s63, 2
  s_add_u32 s3, s3, 160288
  v_mov_b32 v22, s3
  v_mov_b32 v23, 1
  s_mov_b64 exec, 1
  ds_add_u32 v22, v23
  s_mov_b64 exec, -1
  s_cmp_gt_u32 s73, 52
  s_cbranch_scc1 L_nored
  s_mov_b32 s80, 200000
  s_waitcnt vmcnt(0)
L_red:
  buffer_load_dwordx4 v[4:7], v20, s[16:19], s66 offen sc1
  buffer_load_dwordx4 v[8:11], v20, s[16:19], s67 offen sc1
  s_waitcnt vmcnt(0)
  v_xor_b32 v12, s40, v4
  v_bitop3_b32 v12, v12, v5, s41 bitop3:0xf6
  v_bitop3_b32 v12, v12, v6, s48 bitop3:0xf6
  v_bitop3_b32 v12, v12, v7, s49 bitop3:0xf6
  v_bitop3_b32 v12, v12, v8, s40 bitop3:0xf6
  v_bitop3_b32 v12, v12, v9, s41 bitop3:0xf6
  v_bitop3_b32 v12, v12, v10, s48 bitop3:0xf6
  v_bitop3_b32 v12, v12, v11, s49 bitop3:0xf6
  v_and_b32 v12, 0xff, v12
  v_cmp_ne_u32 vcc, 0, v12
  s_cbranch_vccz L_redok
  s_sleep 1
  s_sub_u32 s80, s80, 1
  s_cbranch_scc0 L_red
L_redok:
  v_add_f32 v4, v4, v8
  v_add_f32 v5, v5, v9
  v_add_f32 v6, v6, v10
  v_add_f32 v7, v7, v11
  s_nop 1
  v_add_f32_dpp v4, v4, v4 row_ror:8 row_mask:0xf bank_mask:0xf
  v_add_f32_dpp v5, v5, v5 row_ror:8 row_mask:0xf bank_mask:0xf
  v_add_f32_dpp v6, v6, v6 row_ror:8 row_mask:0xf bank_mask:0xf
  v_add_f32_dpp v7, v7, v7 row_ror:8 row_mask:0xf bank_mask:0xf
  v_mov_b32 v8, v4
  v_mov_b32 v9, v5
  v_mov_b32 v10, v6
  v_mov_b32 v11, v7
  s_nop 1
  v_permlane16_swap_b32 v4, v8
  v_permlane16_swap_b32 v5, v9
  v_permlane16_swap_b32 v6, v10
  v_permlane16_swap_b32 v7, v11
  s_nop 0
  v_add_f32 v4, v4, v8
  v_add_f32 v5, v5, v9
  v_add_f32 v6, v6, v10
  v_add_f32 v7, v7, v11
  v_mov_b32 v8, v4
  v_mov_b32 v9, v5
  v_mov_b32 v10, v6
  v_mov_b32 v11, v7
  s_nop 1
  v_permlane32_swap_b32 v4, v8
  v_permlane32_swap_b32 v5, v9
  v_permlane32_swap_b32 v6, v10
  v_permlane32_swap_b32 v7, v11
  s_nop 0
  v_add_f32 v4, v4, v8
  v_add_f32 v5, v5, v9
  v_add_f32 v6, v6, v10
  v_add_f32 v7, v7, v11
  v_bfi_b32 v4, v3, s40, v4
  v_bfi_b32 v5, v3, s41, v5
  v_bfi_b32 v6, v3, s48, v6
  v_bfi_b32 v7, v3, s49, v7
  s_mov_b64 exec, 0xff
  buffer_store_dwordx4 v[4:7], v21, s[16:19], s75 offen sc1
  s_mov_b64 exec, -1
L_nored:
  v_mov_b32 v22, 160268
  v_mov_b32 v23, 1
  s_mov_b64 exec, 1
  ds_add_u32 v22, v23
  s_mov_b64 exec, -1
  s_setprio 0
  s_branch L_la
L_lq1:
  s_lshr_b32 s73, s63, 1
  s_and_b32 s74, s63, 1
  s_lshl_b32 s3, s59, 1
  s_add_u32 s3, s3, s74
  s_add_u32 s3, s3, 48
  s_lshl_b32 s66, s58, 1
  s_add_u32 s66, s66, s73
  s_mul_i32 s66, s66, 68
  s_add_u32 s66, s66, s3
  s_lshl_b32 s66, s66, 12
  s_lshr_b32 s3, s59, 1
  s_add_u32 s3, s3, 64
  s_lshl_b32 s67, s58, 1
  s_add_u32 s67, s67, s73
  s_mul_i32 s67, s67, 68
  s_add_u32 s67, s67, s3
  s_lshl_b32 s67, s67, 12
  s_lshl_b32 s3, s59, 1
  s_add_u32 s3, s3, s74
  s_and_b32 s3, s3, 3
  s_lshl_b32 s3, s3, 8
  s_add_u32 s67, s67, s3
  s_lshl_b32 s3, s63, 10
  s_add_u32 s75, s75, s3
  s_waitcnt vmcnt(0)
  s_lshl_b32 s3, s63, 2
  s_add_u32 s3, s3, 160288
  v_mov_b32 v22, s3
  v_mov_b32 v23, 1
  s_mov_b64 exec, 1
  ds_add_u32 v22, v23
  s_mov_b64 exec, -1
  v_lshrrev_b32 v4, 1, v254
  v_add_u32 v4, 156672, v4
  ds_write_b64 v4, v[252:253]
  v_lshlrev_b32 v3, 2, v0
  s_mul_i32 s3, s56, 0x1111
  s_add_u32 s3, s3, 0xa842
  v_bfe_u32 v3, s3, v3, 4
  v_lshlrev_b32 v3, 2, v3
  s_mov_b32 s80, 200000
  s_mov_b64 exec, 0xf
Lpoll_hq_5:
  buffer_load_dword v4, v3, s[16:19], s76 offen sc1
  s_waitcnt vmcnt(0)
  v_cmp_ne_u32 vcc, s62, v4
  s_cbranch_vccz Lpoll_hq_5_d
  s_sleep 2
  s_sub_u32 s80, s80, 1
  s_cbranch_scc0 Lpoll_hq_5
Lpoll_hq_5_d:
  s_mov_b64 exec, -1
  s_setprio 1
  s_add_u32 s3, s44, 8192
  buffer_load_dwordx4 v[224:227], v1, s[16:19], s3 offen offset:0 sc1
  buffer_load_dwordx4 v[228:231], v1, s[16:19], s3 offen offset:1024 sc1
  buffer_load_dwordx4 v[232:235], v1, s[16:19], s3 offen offset:2048 sc1
  buffer_load_dwordx4 v[236:239], v1, s[16:19], s3 offen offset:3072 sc1
  s_add_u32 s3, s44, 16384
  buffer_load_dwordx4 v[240:243], v1, s[16:19], s3 offen offset:0 sc1
  buffer_load_dwordx4 v[244:247], v1, s[16:19], s3 offen offset:1024 sc1
  buffer_load_dwordx4 v[248:251], v1, s[16:19], s3 offen offset:2048 sc1
  buffer_load_dwordx4 v[252:255], v1, s[16:19], s3 offen offset:3072 sc1
  s_waitcnt vmcnt(4)
  v_mfma_f32_16x16x32_bf16 v[4:7], v[84:87], v[224:227], 0
  v_mfma_f32_16x16x32_bf16 v[24:27], v[84:87], v[228:231], 0
  v_mfma_f32_16x16x32_bf16 v[44:47], v[84:87], v[232:235], 0
  v_mfma_f32_16x16x32_bf16 v[64:67], v[84:87], v[236:239], 0
  v_mfma_f32_16x16x32_bf16 v[8:11], v[88:91], v[224:227], 0
  v_mfma_f32_16x16x32_bf16 v[28:31], v[88:91], v[228:231], 0
  v_mfma_f32_16x16x32_bf16 v[48:51], v[88:91], v[232:235], 0
  v_mfma_f32_16x16x32_bf16 v[68:71], v[88:91], v[236:239], 0
  v_mfma_f32_16x16x32_bf16 v[12:15], v[92:95], v[224:227], 0
  v_mfma_f32_16x16x32_bf16 v[32:35], v[92:95], v[228:231], 0
  v_mfma_f32_16x16x32_bf16 v[52:55], v[92:95], v[232:235], 0
  v_mfma_f32_16x16x32_bf16 v[72:75], v[92:95], v[236:239], 0
  v_mfma_f32_16x16x32_bf16 v[16:19], v[96:99], v[224:227], 0
  v_mfma_f32_16x16x32_bf16 v[36:39], v[96:99], v[228:231], 0
  v_mfma_f32_16x16x32_bf16 v[56:59], v[96:99], v[232:235], 0
  v_mfma_f32_16x16x32_bf16 v[76:79], v[96:99], v[236:239], 0
  v_mfma_f32_16x16x32_bf16 v[20:23], v[100:103], v[224:227], 0
  v_mfma_f32_16x16x32_bf16 v[40:43], v[100:103], v[228:231], 0
  v_mfma_f32_16x16x32_bf16 v[60:63], v[100:103], v[232:235], 0
  v_mfma_f32_16x16x32_bf16 v[80:83], v[100:103], v[236:239], 0
  s_add_u32 s3, s44, 32768
  buffer_load_dwordx4 v[224:227], v1, s[16:19], s3 offen offset:0 sc1
  buffer_load_dwordx4 v[228:231], v1, s[16:19], s3 offen offset:1024 sc1
  buffer_load_dwordx4 v[232:235], v1, s[16:19], s3 offen offset:2048 sc1
  buffer_load_dwordx4 v[236:239], v1, s[16:19], s3 offen offset:3072 sc1
  s_waitcnt vmcnt(4)
  v_mfma_f32_16x16x32_bf16 v[4:7], v[104:107], v[240:243], v[4:7]
  v_mfma_f32_16x16x32_bf16 v[24:27], v[104:107], v[244:247], v[24:27]
  v_mfma_f32_16x16x32_bf16 v[44:47], v[104:107], v[248:251], v[44:47]
  v_mfma_f32_16x16x32_bf16 v[64:67], v[104:107], v[252:255], v[64:67]
  v_mfma_f32_16x16x32_bf16 v[8:11], v[108:111], v[240:243], v[8:11]
  v_mfma_f32_16x16x32_bf16 v[28:31], v[108:111], v[244:247], v[28:31]
  v_mfma_f32_16x16x32_bf16 v[48:51], v[108:111], v[248:251], v[48:51]
  v_mfma_f32_16x16x32_bf16 v[68:71], v[108:111], v[252:255], v[68:71]
  v_mfma_f32_16x16x32_bf16 v[12:15], v[112:115], v[240:243], v[12:15]
  v_mfma_f32_16x16x32_bf16 v[32:35], v[112:115], v[244:247], v[32:35]
  v_mfma_f32_16x16x32_bf16 v[52:55], v[112:115], v[248:251], v[52:55]
  v_mfma_f32_16x16x32_bf16 v[72:75], v[112:115], v[252:255], v[72:75]
  v_mfma_f32_16x16x32_bf16 v[16:19], v[116:119], v[240:243], v[16:19]
  v_mfma_f32_16x16x32_bf16 v[36:39], v[116:119], v[244:247], v[36:39]
  v_mfma_f32_16x16x32_bf16 v[56:59], v[116:119], v[248:251], v[56:59]
  v_mfma_f32_16x16x32_bf16 v[76:79], v[116:119], v[252:255], v[76:79]
  v_mfma_f32_16x16x32_bf16 v[20:23], v[120:123], v[240:243], v[20:23]
  v_mfma_f32_16x16x32_bf16 v[40:43], v[120:123], v[244:247], v[40:43]
  v_mfma_f32_16x16x32_bf16 v[60:63], v[120:123], v[248:251], v[60:63]
  v_mfma_f32_16x16x32_bf16 v[80:83], v[120:123], v[252:255], v[80:83]
  s_add_u32 s3, s44, 40960
  buffer_load_dwordx4 v[240:243], v1, s[16:19], s3 offen offset:0 sc1
  buffer_load_dwordx4 v[244:247], v1, s[16:19], s3 offen offset:1024 sc1
  buffer_load_dwordx4 v[248:251], v1, s[16:19], s3 offen offset:2048 sc1
  buffer_load_dwordx4 v[252:255], v1, s[16:19], s3 offen offset:3072 sc1
  s_waitcnt vmcnt(4)
  v_mfma_f32_16x16x32_bf16 v[4:7], v[124:127], v[224:227], v[4:7]
  v_mfma_f32_16x16x32_bf16 v[24:27], v[124:127], v[228:231], v[24:27]
  v_mfma_f32_16x16x32_bf16 v[44:47], v[124:127], v[232:235], v[44:47]
  v_mfma_f32_16x16x32_bf16 v[64:67], v[124:127], v[236:239], v[64:67]
  v_mfma_f32_16x16x32_bf16 v[8:11], v[128:131], v[224:227], v[8:11]
  v_mfma_f32_16x16x32_bf16 v[28:31], v[128:131], v[228:231], v[28:31]
  v_mfma_f32_16x16x32_bf16 v[48:51], v[128:131], v[232:235], v[48:51]
  v_mfma_f32_16x16x32_bf16 v[68:71], v[128:131], v[236:239], v[68:71]
  v_mfma_f32_16x16x32_bf16 v[12:15], v[132:135], v[224:227], v[12:15]
  v_mfma_f32_16x16x32_bf16 v[32:35], v[132:135], v[228:231], v[32:35]
  v_mfma_f32_16x16x32_bf16 v[52:55], v[132:135], v[232:235], v[52:55]
  v_mfma_f32_16x16x32_bf16 v[72:75], v[132:135], v[236:239], v[72:75]
  v_mfma_f32_16x16x32_bf16 v[16:19], v[136:139], v[224:227], v[16:19]
  v_mfma_f32_16x16x32_bf16 v[36:39], v[136:139], v[228:231], v[36:39]
  v_mfma_f32_16x16x32_bf16 v[56:59], v[136:139], v[232:235], v[56:59]
  v_mfma_f32_16x16x32_bf16 v[76:79], v[136:139], v[236:239], v[76:79]
  v_mfma_f32_16x16x32_bf16 v[20:23], v[140:143], v[224:227], v[20:23]
  v_mfma_f32_16x16x32_bf16 v[40:43], v[140:143], v[228:231], v[40:43]
  v_mfma_f32_16x16x32_bf16 v[60:63], v[140:143], v[232:235], v[60:63]
  v_mfma_f32_16x16x32_bf16 v[80:83], v[140:143], v[236:239], v[80:83]
  v_cndmask_b32 v118, v1, v2, s[78:79]
  buffer_load_dwordx4 v[108:111], v1, s[16:19], s75 offen sc1
  buffer_load_dwordx4 v[112:115], v118, s[16:19], s75 offen sc1
  s_waitcnt vmcnt(2)
  v_mfma_f32_16x16x32_bf16 v[4:7], v[144:147], v[240:243], v[4:7]
  v_mfma_f32_16x16x32_bf16 v[24:27], v[144:147], v[244:247], v[24:27]
  v_mfma_f32_16x16x32_bf16 v[44:47], v[144:147], v[248:251], v[44:47]
  v_mfma_f32_16x16x32_bf16 v[64:67], v[144:147], v[252:255], v[64:67]
  v_mfma_f32_16x16x32_bf16 v[8:11], v[148:151], v[240:243], v[8:11]
  v_mfma_f32_16x16x32_bf16 v[28:31], v[148:151], v[244:247], v[28:31]
  v_mfma_f32_16x16x32_bf16 v[48:51], v[148:151], v[248:251], v[48:51]
  v_mfma_f32_16x16x32_bf16 v[68:71], v[148:151], v[252:255], v[68:71]
  v_mfma_f32_16x16x32_bf16 v[12:15], v[152:155], v[240:243], v[12:15]
  v_mfma_f32_16x16x32_bf16 v[32:35], v[152:155], v[244:247], v[32:35]
  v_mfma_f32_16x16x32_bf16 v[52:55], v[152:155], v[248:251], v[52:55]
  v_mfma_f32_16x16x32_bf16 v[72:75], v[152:155], v[252:255], v[72:75]
  v_mfma_f32_16x16x32_bf16 v[16:19], v[156:159], v[240:243], v[16:19]
  v_mfma_f32_16x16x32_bf16 v[36:39], v[156:159], v[244:247], v[36:39]
  v_mfma_f32_16x16x32_bf16 v[56:59], v[156:159], v[248:251], v[56:59]
  v_mfma_f32_16x16x32_bf16 v[76:79], v[156:159], v[252:255], v[76:79]
  v_mfma_f32_16x16x32_bf16 v[20:23], v[160:163], v[240:243], v[20:23]
  v_mfma_f32_16x16x32_bf16 v[40:43], v[160:163], v[244:247], v[40:43]
  v_mfma_f32_16x16x32_bf16 v[60:63], v[160:163], v[248:251], v[60:63]
  v_mfma_f32_16x16x32_bf16 v[80:83], v[160:163], v[252:255], v[80:83]
  s_lshl_b32 s3, s63, 9
  s_add_u32 s3, s3, 156672
  v_lshl_add_u32 v120, v0, 3, s3
  ds_read_b64 v[120:121], v120
  v_and_b32 v124, 15, v0
  v_lshrrev_b32 v123, 4, v0
  s_mul_i32 s3, s74, 4608
  s_add_u32 s3, s3, 147456
  v_lshl_add_u32 v125, v124, 2, v123
  v_lshl_add_u32 v249, v125, 3, s3
  v_lshl_add_u32 v248, v125, 4, s3
  v_and_b32 v126, 3, v124
  v_min_u32 v126, 1, v126
  v_cmp_eq_u32 vcc, 2, v124
  v_lshlrev_b32 v124, 4, v124
  v_lshl_add_u32 v252, v123, 10, v124
  v_cndmask_b32 v126, v126, 0, vcc
  v_add_u32 v126, 40, v126
  v_lshl_add_u32 v126, v126, 2, v123
  v_lshl_add_u32 v251, v126, 3, s3
  v_lshl_add_u32 v250, v126, 4, s3
  v_mov_b32 v253, 0x358637bd
  s_lshl_b32 s3, s63, 2
  s_add_u32 s3, s3, 160272
  v_mov_b32 v254, s3
  s_mov_b32 s80, 4000000
Llw_6:
  ds_read_b32 v255, v254
  s_waitcnt lgkmcnt(0)
  v_cmp_ne_u32 vcc, 1, v255
  s_cbranch_vccz Llw_6_d
  s_sleep 2
  s_sub_u32 s80, s80, 1
  s_cbranch_scc0 Llw_6
Llw_6_d:
  s_setprio 2
  s_mul_i32 s3, s63, 6144
  s_add_u32 s3, s3, 122880
  v_add_u32 v128, s3, v1
  v_lshl_add_u32 v129, v0, 3, s3
  ds_read_b128 v[224:227], v128 offset:0
  ds_read_b64 v[228:229], v129 offset:4096
  ds_read_b128 v[230:233], v128 offset:1024
  ds_read_b64 v[234:235], v129 offset:4608
  ds_read_b128 v[236:239], v128 offset:2048
  ds_read_b64 v[240:241], v129 offset:5120
  ds_read_b128 v[242:245], v128 offset:3072
  ds_read_b64 v[246:247], v129 offset:5632
  s_mov_b32 s80, 200000
L_gather:
  s_waitcnt vmcnt(0)
  v_xor_b32 v116, s40, v108
  v_bitop3_b32 v116, v116, v109, s41 bitop3:0xf6
  v_bitop3_b32 v116, v116, v110, s48 bitop3:0xf6
  v_bitop3_b32 v116, v116, v111, s49 bitop3:0xf6
  v_bitop3_b32 v116, v116, v112, s40 bitop3:0xf6
  v_bitop3_b32 v116, v116, v113, s41 bitop3:0xf6
  v_bitop3_b32 v116, v116, v114, s48 bitop3:0xf6
  v_bitop3_b32 v116, v116, v115, s49 bitop3:0xf6
  v_and_b32 v116, 0xff, v116
  v_cmp_ne_u32 vcc, 0, v116
  s_cbranch_vccz L_gatherok
  s_sleep 2
  buffer_load_dwordx4 v[108:111], v1, s[16:19], s75 offen sc1
  buffer_load_dwordx4 v[112:115], v118, s[16:19], s75 offen sc1
  s_sub_u32 s80, s80, 1
  s_cbranch_scc0 L_gather
  s_waitcnt vmcnt(0)
L_gatherok:
  v_cvt_pk_bf16_f32 v108, v108, v109
  v_cvt_pk_bf16_f32 v109, v110, v111
  v_cvt_pk_bf16_f32 v110, v112, v113
  v_cvt_pk_bf16_f32 v111, v114, v115
  ds_write_b64 v120, v[108:109]
  ds_write_b64 v121, v[110:111]
  s_waitcnt lgkmcnt(0)
  v_mov_b32 v254, 160256
  v_mov_b32 v255, 1
  s_mov_b64 exec, 1
  ds_add_u32 v254, v255
  s_mov_b64 exec, -1
  v_mov_b32 v254, 160256
  s_mov_b32 s80, 4000000
Llw_7:
  ds_read_b32 v255, v254
  s_waitcnt lgkmcnt(0)
  v_cmp_ne_u32 vcc, 4, v255
  s_cbranch_vccz Llw_7_d
  s_sub_u32 s80, s80, 1
  s_cbranch_scc0 Llw_7
Llw_7_d:
  ds_read_b128 v[84:87], v248 offset:0
  ds_read_b128 v[88:91], v248 offset:1024
  ds_read_b128 v[92:95], v248 offset:2048
  ds_read_b128 v[96:99], v250
  ds_read_b64 v[100:101], v249 offset:3584
  ds_read_b64 v[102:103], v249 offset:4096
  ds_read_b64 v[104:105], v251 offset:3072
  s_waitcnt lgkmcnt(0)
  v_mfma_f32_16x16x32_bf16 v[108:111], v[84:87], v[224:227], 0
  v_mfma_f32_16x16x32_bf16 v[112:115], v[88:91], v[224:227], 0
  v_mfma_f32_16x16x32_bf16 v[116:119], v[92:95], v[224:227], 0
  v_mfma_f32_16x16x32_bf16 v[120:123], v[96:99], v[224:227], 0
  v_mfma_f32_16x16x32_bf16 v[124:127], v[84:87], v[230:233], 0
  v_mfma_f32_16x16x32_bf16 v[128:131], v[88:91], v[230:233], 0
  v_mfma_f32_16x16x32_bf16 v[132:135], v[92:95], v[230:233], 0
  v_mfma_f32_16x16x32_bf16 v[136:139], v[96:99], v[230:233], 0
  v_mfma_f32_16x16x32_bf16 v[140:143], v[84:87], v[236:239], 0
  v_mfma_f32_16x16x32_bf16 v[144:147], v[88:91], v[236:239], 0
  v_mfma_f32_16x16x32_bf16 v[148:151], v[92:95], v[236:239], 0
  v_mfma_f32_16x16x32_bf16 v[152:155], v[96:99], v[236:239], 0
  v_mfma_f32_16x16x16_bf16 v[120:123], v[104:105], v[228:229], v[120:123]
  v_mfma_f32_16x16x16_bf16 v[112:115], v[100:101], v[228:229], v[112:115]
  v_mfma_f32_16x16x16_bf16 v[116:119], v[102:103], v[228:229], v[116:119]
  v_mfma_f32_16x16x16_bf16 v[136:139], v[104:105], v[234:235], v[136:139]
  v_mfma_f32_16x16x16_bf16 v[128:131], v[100:101], v[234:235], v[128:131]
  v_mfma_f32_16x16x16_bf16 v[132:135], v[102:103], v[234:235], v[132:135]
  v_mfma_f32_16x16x16_bf16 v[152:155], v[104:105], v[240:241], v[152:155]
  v_mfma_f32_16x16x16_bf16 v[144:147], v[100:101], v[240:241], v[144:147]
  v_mfma_f32_16x16x16_bf16 v[148:151], v[102:103], v[240:241], v[148:151]
  v_add_f32 v120, v120, v253
  v_add_f32 v121, v121, v253
  v_add_f32 v122, v122, v253
  v_rcp_f32 v120, v120
  v_rcp_f32 v121, v121
  v_rcp_f32 v122, v122
  v_mul_f32 v108, v108, v120
  v_mul_f32 v109, v109, v120
  v_mul_f32 v110, v110, v120
  v_mul_f32 v111, v111, v120
  v_mul_f32 v116, v116, v121
  v_mul_f32 v117, v117, v121
  v_mul_f32 v118, v118, v121
  v_mul_f32 v119, v119, v121
  v_mul_f32 v112, v112, v122
  v_mul_f32 v113, v113, v122
  v_mul_f32 v114, v114, v122
  v_mul_f32 v115, v115, v122
  v_cvt_pk_bf16_f32 v156, v116, v117
  v_cvt_pk_bf16_f32 v157, v118, v119
  v_cvt_pk_bf16_f32 v224, v108, v109
  v_cvt_pk_bf16_f32 v225, v110, v111
  v_cvt_pk_bf16_f32 v226, v112, v113
  v_cvt_pk_bf16_f32 v227, v114, v115
  v_mfma_f32_16x16x32_bf16 v[108:111], v[84:87], v[242:245], 0
  v_mfma_f32_16x16x32_bf16 v[112:115], v[88:91], v[242:245], 0
  v_mfma_f32_16x16x32_bf16 v[116:119], v[92:95], v[242:245], 0
  v_mfma_f32_16x16x32_bf16 v[120:123], v[96:99], v[242:245], 0
  s_cmp_lg_u32 s54, 0
  s_cbranch_scc0 Lsl_8
  buffer_store_dwordx4 v[224:227], v1, s[16:19], s66 offen offset:0
Lsl_8_b:
  v_add_f32 v136, v136, v253
  v_add_f32 v137, v137, v253
  v_add_f32 v138, v138, v253
  v_rcp_f32 v136, v136
  v_rcp_f32 v137, v137
  v_rcp_f32 v138, v138
  v_add_f32 v152, v152, v253
  v_add_f32 v153, v153, v253
  v_add_f32 v154, v154, v253
  v_rcp_f32 v152, v152
  v_rcp_f32 v153, v153
  v_rcp_f32 v154, v154
  v_mfma_f32_16x16x16_bf16 v[120:123], v[104:105], v[246:247], v[120:123]
  v_mfma_f32_16x16x16_bf16 v[112:115], v[100:101], v[246:247], v[112:115]
  v_mfma_f32_16x16x16_bf16 v[116:119], v[102:103], v[246:247], v[116:119]
  v_mul_f32 v124, v124, v136
  v_mul_f32 v125, v125, v136
  v_mul_f32 v126, v126, v136
  v_mul_f32 v127, v127, v136
  v_mul_f32 v132, v132, v137
  v_mul_f32 v133, v133, v137
  v_mul_f32 v134, v134, v137
  v_mul_f32 v135, v135, v137
  v_mul_f32 v128, v128, v138
  v_mul_f32 v129, v129, v138
  v_mul_f32 v130, v130, v138
  v_mul_f32 v131, v131, v138
  v_cvt_pk_bf16_f32 v158, v132, v133
  v_cvt_pk_bf16_f32 v159, v134, v135
  v_cvt_pk_bf16_f32 v230, v124, v125
  v_cvt_pk_bf16_f32 v231, v126, v127
  v_cvt_pk_bf16_f32 v232, v128, v129
  v_cvt_pk_bf16_f32 v233, v130, v131
  s_cmp_lg_u32 s54, 0
  s_cbranch_scc0 Lsl_9
  buffer_store_dwordx4 v[230:233], v1, s[16:19], s66 offen offset:1024
Lsl_9_b:
  v_add_f32 v120, v120, v253
  v_add_f32 v121, v121, v253
  v_add_f32 v122, v122, v253
  v_rcp_f32 v120, v120
  v_rcp_f32 v121, v121
  v_rcp_f32 v122, v122
  v_mul_f32 v140, v140, v152
  v_mul_f32 v141, v141, v152
  v_mul_f32 v142, v142, v152
  v_mul_f32 v143, v143, v152
  v_mul_f32 v148, v148, v153
  v_mul_f32 v149, v149, v153
  v_mul_f32 v150, v150, v153
  v_mul_f32 v151, v151, v153
  v_mul_f32 v144, v144, v154
  v_mul_f32 v145, v145, v154
  v_mul_f32 v146, v146, v154
  v_mul_f32 v147, v147, v154
  v_cvt_pk_bf16_f32 v160, v148, v149
  v_cvt_pk_bf16_f32 v161, v150, v151
  v_cvt_pk_bf16_f32 v236, v140, v141
  v_cvt_pk_bf16_f32 v237, v142, v143
  v_cvt_pk_bf16_f32 v238, v144, v145
  v_cvt_pk_bf16_f32 v239, v146, v147
  s_cmp_lg_u32 s54, 0
  s_cbranch_scc0 Lsl_10
  buffer_store_dwordx4 v[236:239], v1, s[16:19], s66 offen offset:2048
Lsl_10_b:
  v_mul_f32 v108, v108, v120
  v_mul_f32 v109, v109, v120
  v_mul_f32 v110, v110, v120
  v_mul_f32 v111, v111, v120
  v_mul_f32 v116, v116, v121
  v_mul_f32 v117, v117, v121
  v_mul_f32 v118, v118, v121
  v_mul_f32 v119, v119, v121
  v_mul_f32 v112, v112, v122
  v_mul_f32 v113, v113, v122
  v_mul_f32 v114, v114, v122
  v_mul_f32 v115, v115, v122
  v_cvt_pk_bf16_f32 v162, v116, v117
  v_cvt_pk_bf16_f32 v163, v118, v119
  v_cvt_pk_bf16_f32 v242, v108, v109
  v_cvt_pk_bf16_f32 v243, v110, v111
  v_cvt_pk_bf16_f32 v244, v112, v113
  v_cvt_pk_bf16_f32 v245, v114, v115
  s_cmp_lg_u32 s54, 0
  s_cbranch_scc0 Lsl_11
  buffer_store_dwordx4 v[242:245], v1, s[16:19], s66 offen offset:3072
Lsl_11_b:
  v_permlane16_swap_b32 v156, v158
  v_permlane16_swap_b32 v157, v159
  v_permlane16_swap_b32 v160, v162
  v_permlane16_swap_b32 v161, v163
  s_nop 1
  v_permlane32_swap_b32 v156, v160
  v_permlane32_swap_b32 v157, v161
  v_permlane32_swap_b32 v158, v162
  v_permlane32_swap_b32 v159, v163
  s_cmp_lg_u32 s54, 0
  s_cbranch_scc0 Lsl_12
  buffer_store_dwordx4 v[156:159], v252, s[16:19], s67 offen
Lsl_12_b:
  s_lshl_b32 s3, s58, 1
  s_add_u32 s3, s3, s73
  s_mul_i32 s3, s3, 240
  s_lshr_b32 s80, s66, 10
  s_add_u32 s3, s3, s80
  s_add_u32 s3, s3, 0xd14000
  v_mov_b32 v254, s62
  v_mov_b32 v255, 0
  s_mov_b64 exec, 1
  s_waitcnt vmcnt(0)
  s_cmp_lg_u32 s54, 0
  s_cbranch_scc0 Lsl_13
  buffer_store_dword v254, v255, s[16:19], s3 offen
Lsl_13_b:
  s_mov_b64 exec, -1
  s_nop 0
  v_mov_b32 v252, 160268
  v_mov_b32 v253, 1
  s_mov_b64 exec, 1
  ds_add_u32 v252, v253
  s_mov_b64 exec, -1
  s_setprio 0
  s_add_u32 s3, s42, 122880
  buffer_load_dwordx4 v[84:87], v1, s[16:19], s3 offen offset:0 sc1
  buffer_load_dwordx4 v[88:91], v1, s[16:19], s3 offen offset:1024 sc1
  buffer_load_dwordx4 v[92:95], v1, s[16:19], s3 offen offset:2048 sc1
  buffer_load_dwordx4 v[96:99], v1, s[16:19], s3 offen offset:3072 sc1
  buffer_load_dwordx4 v[100:103], v2, s[16:19], s3 offen sc1
  s_add_u32 s3, s43, 0
  buffer_load_dwordx4 v[104:107], v1, s[16:19], s3 offen offset:0 sc1
  buffer_load_dwordx4 v[108:111], v1, s[16:19], s3 offen offset:1024 sc1
  buffer_load_dwordx4 v[112:115], v1, s[16:19], s3 offen offset:2048 sc1
  buffer_load_dwordx4 v[116:119], v1, s[16:19], s3 offen offset:3072 sc1
  buffer_load_dwordx4 v[120:123], v2, s[16:19], s3 offen sc1
  s_branch L_oslow2
L_la:
  v_lshlrev_b32 v3, 2, v0
  s_mul_i32 s3, s56, 0x1111
  s_add_u32 s3, s3, 0xa842
  v_bfe_u32 v3, s3, v3, 4
  v_lshlrev_b32 v3, 2, v3
  s_mov_b32 s80, 200000
  s_mov_b64 exec, 0xf
Lpoll_hl_14:
  buffer_load_dword v4, v3, s[16:19], s76 offen sc1
  s_waitcnt vmcnt(0)
  v_cmp_ne_u32 vcc, s62, v4
  s_cbranch_vccz Lpoll_hl_14_d
  s_sleep 2
  s_sub_u32 s80, s80, 1
  s_cbranch_scc0 Lpoll_hl_14
Lpoll_hl_14_d:
  s_mov_b64 exec, -1
  s_setprio 1
  s_add_u32 s3, s44, 8192
  buffer_load_dwordx4 v[224:227], v1, s[16:19], s3 offen offset:0 sc1
  buffer_load_dwordx4 v[228:231], v1, s[16:19], s3 offen offset:1024 sc1
  buffer_load_dwordx4 v[232:235], v1, s[16:19], s3 offen offset:2048 sc1
  buffer_load_dwordx4 v[236:239], v1, s[16:19], s3 offen offset:3072 sc1
  s_add_u32 s3, s44, 16384
  buffer_load_dwordx4 v[240:243], v1, s[16:19], s3 offen offset:0 sc1
  buffer_load_dwordx4 v[244:247], v1, s[16:19], s3 offen offset:1024 sc1
  buffer_load_dwordx4 v[248:251], v1, s[16:19], s3 offen offset:2048 sc1
  buffer_load_dwordx4 v[252:255], v1, s[16:19], s3 offen offset:3072 sc1
  s_waitcnt vmcnt(4)
  v_mfma_f32_16x16x32_bf16 v[4:7], v[84:87], v[224:227], 0
  v_mfma_f32_16x16x32_bf16 v[24:27], v[84:87], v[228:231], 0
  v_mfma_f32_16x16x32_bf16 v[44:47], v[84:87], v[232:235], 0
  v_mfma_f32_16x16x32_bf16 v[64:67], v[84:87], v[236:239], 0
  v_mfma_f32_16x16x32_bf16 v[8:11], v[88:91], v[224:227], 0
  v_mfma_f32_16x16x32_bf16 v[28:31], v[88:91], v[228:231], 0
  v_mfma_f32_16x16x32_bf16 v[48:51], v[88:91], v[232:235], 0
  v_mfma_f32_16x16x32_bf16 v[68:71], v[88:91], v[236:239], 0
  v_mfma_f32_16x16x32_bf16 v[12:15], v[92:95], v[224:227], 0
  v_mfma_f32_16x16x32_bf16 v[32:35], v[92:95], v[228:231], 0
  v_mfma_f32_16x16x32_bf16 v[52:55], v[92:95], v[232:235], 0
  v_mfma_f32_16x16x32_bf16 v[72:75], v[92:95], v[236:239], 0
  v_mfma_f32_16x16x32_bf16 v[16:19], v[96:99], v[224:227], 0
  v_mfma_f32_16x16x32_bf16 v[36:39], v[96:99], v[228:231], 0
  v_mfma_f32_16x16x32_bf16 v[56:59], v[96:99], v[232:235], 0
  v_mfma_f32_16x16x32_bf16 v[76:79], v[96:99], v[236:239], 0
  v_mfma_f32_16x16x32_bf16 v[20:23], v[100:103], v[224:227], 0
  v_mfma_f32_16x16x32_bf16 v[40:43], v[100:103], v[228:231], 0
  v_mfma_f32_16x16x32_bf16 v[60:63], v[100:103], v[232:235], 0
  v_mfma_f32_16x16x32_bf16 v[80:83], v[100:103], v[236:239], 0
  s_add_u32 s3, s44, 32768
  buffer_load_dwordx4 v[224:227], v1, s[16:19], s3 offen offset:0 sc1
  buffer_load_dwordx4 v[228:231], v1, s[16:19], s3 offen offset:1024 sc1
  buffer_load_dwordx4 v[232:235], v1, s[16:19], s3 offen offset:2048 sc1
  buffer_load_dwordx4 v[236:239], v1, s[16:19], s3 offen offset:3072 sc1
  s_waitcnt vmcnt(4)
  v_mfma_f32_16x16x32_bf16 v[4:7], v[104:107], v[240:243], v[4:7]
  v_mfma_f32_16x16x32_bf16 v[24:27], v[104:107], v[244:247], v[24:27]
  v_mfma_f32_16x16x32_bf16 v[44:47], v[104:107], v[248:251], v[44:47]
  v_mfma_f32_16x16x32_bf16 v[64:67], v[104:107], v[252:255], v[64:67]
  v_mfma_f32_16x16x32_bf16 v[8:11], v[108:111], v[240:243], v[8:11]
  v_mfma_f32_16x16x32_bf16 v[28:31], v[108:111], v[244:247], v[28:31]
  v_mfma_f32_16x16x32_bf16 v[48:51], v[108:111], v[248:251], v[48:51]
  v_mfma_f32_16x16x32_bf16 v[68:71], v[108:111], v[252:255], v[68:71]
  v_mfma_f32_16x16x32_bf16 v[12:15], v[112:115], v[240:243], v[12:15]
  v_mfma_f32_16x16x32_bf16 v[32:35], v[112:115], v[244:247], v[32:35]
  v_mfma_f32_16x16x32_bf16 v[52:55], v[112:115], v[248:251], v[52:55]
  v_mfma_f32_16x16x32_bf16 v[72:75], v[112:115], v[252:255], v[72:75]
  v_mfma_f32_16x16x32_bf16 v[16:19], v[116:119], v[240:243], v[16:19]
  v_mfma_f32_16x16x32_bf16 v[36:39], v[116:119], v[244:247], v[36:39]
  v_mfma_f32_16x16x32_bf16 v[56:59], v[116:119], v[248:251], v[56:59]
  v_mfma_f32_16x16x32_bf16 v[76:79], v[116:119], v[252:255], v[76:79]
  v_mfma_f32_16x16x32_bf16 v[20:23], v[120:123], v[240:243], v[20:23]
  v_mfma_f32_16x16x32_bf16 v[40:43], v[120:123], v[244:247], v[40:43]
  v_mfma_f32_16x16x32_bf16 v[60:63], v[120:123], v[248:251], v[60:63]
  v_mfma_f32_16x16x32_bf16 v[80:83], v[120:123], v[252:255], v[80:83]
  s_add_u32 s3, s44, 40960
  buffer_load_dwordx4 v[240:243], v1, s[16:19], s3 offen offset:0 sc1
  buffer_load_dwordx4 v[244:247], v1, s[16:19], s3 offen offset:1024 sc1
  buffer_load_dwordx4 v[248:251], v1, s[16:19], s3 offen offset:2048 sc1
  buffer_load_dwordx4 v[252:255], v1, s[16:19], s3 offen offset:3072 sc1
  v_lshlrev_b32 v3, 2, v0
  s_mov_b64 exec, 15
  buffer_load_dword v3, v3, s[16:19], s77 offen sc1
  s_mov_b64 exec, -1
  s_add_u32 s3, s42, 122880
  buffer_load_dwordx4 v[84:87], v1, s[16:19], s3 offen offset:0 sc1
  buffer_load_dwordx4 v[88:91], v1, s[16:19], s3 offen offset:1024 sc1
  buffer_load_dwordx4 v[92:95], v1, s[16:19], s3 offen offset:2048 sc1
  buffer_load_dwordx4 v[96:99], v1, s[16:19], s3 offen offset:3072 sc1
  buffer_load_dwordx4 v[100:103], v2, s[16:19], s3 offen sc1
  s_add_u32 s3, s43, 0
  buffer_load_dwordx4 v[104:107], v1, s[16:19], s3 offen offset:0 sc1
  buffer_load_dwordx4 v[108:111], v1, s[16:19], s3 offen offset:1024 sc1
  buffer_load_dwordx4 v[112:115], v1, s[16:19], s3 offen offset:2048 sc1
  buffer_load_dwordx4 v[116:119], v1, s[16:19], s3 offen offset:3072 sc1
  buffer_load_dwordx4 v[120:123], v2, s[16:19], s3 offen sc1
  s_waitcnt vmcnt(15)
  v_mfma_f32_16x16x32_bf16 v[4:7], v[124:127], v[224:227], v[4:7]
  v_mfma_f32_16x16x32_bf16 v[24:27], v[124:127], v[228:231], v[24:27]
  v_mfma_f32_16x16x32_bf16 v[44:47], v[124:127], v[232:235], v[44:47]
  v_mfma_f32_16x16x32_bf16 v[64:67], v[124:127], v[236:239], v[64:67]
  v_mfma_f32_16x16x32_bf16 v[8:11], v[128:131], v[224:227], v[8:11]
  v_mfma_f32_16x16x32_bf16 v[28:31], v[128:131], v[228:231], v[28:31]
  v_mfma_f32_16x16x32_bf16 v[48:51], v[128:131], v[232:235], v[48:51]
  v_mfma_f32_16x16x32_bf16 v[68:71], v[128:131], v[236:239], v[68:71]
  v_mfma_f32_16x16x32_bf16 v[12:15], v[132:135], v[224:227], v[12:15]
  v_mfma_f32_16x16x32_bf16 v[32:35], v[132:135], v[228:231], v[32:35]
  v_mfma_f32_16x16x32_bf16 v[52:55], v[132:135], v[232:235], v[52:55]
  v_mfma_f32_16x16x32_bf16 v[72:75], v[132:135], v[236:239], v[72:75]
  v_mfma_f32_16x16x32_bf16 v[16:19], v[136:139], v[224:227], v[16:19]
  v_mfma_f32_16x16x32_bf16 v[36:39], v[136:139], v[228:231], v[36:39]
  v_mfma_f32_16x16x32_bf16 v[56:59], v[136:139], v[232:235], v[56:59]
  v_mfma_f32_16x16x32_bf16 v[76:79], v[136:139], v[236:239], v[76:79]
  v_mfma_f32_16x16x32_bf16 v[20:23], v[140:143], v[224:227], v[20:23]
  v_mfma_f32_16x16x32_bf16 v[40:43], v[140:143], v[228:231], v[40:43]
  v_mfma_f32_16x16x32_bf16 v[60:63], v[140:143], v[232:235], v[60:63]
  v_mfma_f32_16x16x32_bf16 v[80:83], v[140:143], v[236:239], v[80:83]
  s_waitcnt vmcnt(10)
  v_cmp_ne_u32 vcc, s62, v3
  s_and_b32 s83, vcc_lo, 15
  s_cbranch_scc1 L_oslow
  buffer_load_dwordx4 v[124:127], v1, s[16:19], s68 offen offset:0 sc1
  buffer_load_dwordx4 v[128:131], v1, s[16:19], s69 offen offset:0 sc1
  buffer_load_dwordx4 v[132:135], v1, s[16:19], s70 offen offset:0 sc1
  buffer_load_dwordx4 v[136:139], v1, s[16:19], s71 offen offset:0 sc1
  buffer_load_dwordx4 v[140:143], v1, s[16:19], s38 offen offset:0 sc1
  v_mfma_f32_16x16x32_bf16 v[4:7], v[144:147], v[240:243], v[4:7]
  v_mfma_f32_16x16x32_bf16 v[24:27], v[144:147], v[244:247], v[24:27]
  v_mfma_f32_16x16x32_bf16 v[44:47], v[144:147], v[248:251], v[44:47]
  v_mfma_f32_16x16x32_bf16 v[64:67], v[144:147], v[252:255], v[64:67]
  v_mfma_f32_16x16x32_bf16 v[8:11], v[148:151], v[240:243], v[8:11]
  v_mfma_f32_16x16x32_bf16 v[28:31], v[148:151], v[244:247], v[28:31]
  v_mfma_f32_16x16x32_bf16 v[48:51], v[148:151], v[248:251], v[48:51]
  v_mfma_f32_16x16x32_bf16 v[68:71], v[148:151], v[252:255], v[68:71]
  v_mfma_f32_16x16x32_bf16 v[12:15], v[152:155], v[240:243], v[12:15]
  v_mfma_f32_16x16x32_bf16 v[32:35], v[152:155], v[244:247], v[32:35]
  v_mfma_f32_16x16x32_bf16 v[52:55], v[152:155], v[248:251], v[52:55]
  v_mfma_f32_16x16x32_bf16 v[72:75], v[152:155], v[252:255], v[72:75]
  v_mfma_f32_16x16x32_bf16 v[16:19], v[156:159], v[240:243], v[16:19]
  v_mfma_f32_16x16x32_bf16 v[36:39], v[156:159], v[244:247], v[36:39]
  v_mfma_f32_16x16x32_bf16 v[56:59], v[156:159], v[248:251], v[56:59]
  v_mfma_f32_16x16x32_bf16 v[76:79], v[156:159], v[252:255], v[76:79]
  v_mfma_f32_16x16x32_bf16 v[20:23], v[160:163], v[240:243], v[20:23]
  v_mfma_f32_16x16x32_bf16 v[40:43], v[160:163], v[244:247], v[40:43]
  v_mfma_f32_16x16x32_bf16 v[60:63], v[160:163], v[248:251], v[60:63]
  v_mfma_f32_16x16x32_bf16 v[80:83], v[160:163], v[252:255], v[80:83]
  buffer_load_dwordx4 v[144:147], v1, s[16:19], s68 offen offset:1024 sc1
  buffer_load_dwordx4 v[148:151], v1, s[16:19], s69 offen offset:1024 sc1
  buffer_load_dwordx4 v[152:155], v1, s[16:19], s70 offen offset:1024 sc1
  buffer_load_dwordx4 v[156:159], v1, s[16:19], s71 offen offset:1024 sc1
  buffer_load_dwordx4 v[160:163], v1, s[16:19], s38 offen offset:1024 sc1
  buffer_load_dwordx4 v[224:227], v1, s[16:19], s68 offen offset:2048 sc1
  buffer_load_dwordx4 v[228:231], v1, s[16:19], s69 offen offset:2048 sc1
  buffer_load_dwordx4 v[232:235], v1, s[16:19], s70 offen offset:2048 sc1
  buffer_load_dwordx4 v[236:239], v1, s[16:19], s71 offen offset:2048 sc1
  buffer_load_dwordx4 v[240:243], v1, s[16:19], s38 offen offset:2048 sc1
L_oback:
  s_setprio 0
  v_and_b32 v251, 15, v0
  v_lshrrev_b32 v249, 4, v0
  v_bfe_u32 v250, v0, 1, 2
  v_xor_b32 v249, v249, v250
  v_mul_u32_u24 v251, 320, v251
  v_lshl_add_u32 v251, v249, 4, v251
  s_mul_i32 s3, s63, 5120
  s_add_u32 s3, s3, 122880
  v_add_u32 v250, s3, v251
  s_mul_i32 s3, s63, 30720
  v_add_u32 v251, s3, v251
  v_add_u32 v249, 20480, v251
  v_mov_b32 v252, 160304
  v_mov_b32 v253, 1
  s_waitcnt vmcnt(14)
  v_mfma_f32_16x16x32_bf16 v[4:7], v[164:167], v[124:127], v[4:7]
  v_mfma_f32_16x16x32_bf16 v[8:11], v[168:171], v[124:127], v[8:11]
  v_mfma_f32_16x16x32_bf16 v[12:15], v[172:175], v[124:127], v[12:15]
  v_mfma_f32_16x16x32_bf16 v[16:19], v[176:179], v[124:127], v[16:19]
  v_mfma_f32_16x16x32_bf16 v[20:23], v[180:183], v[124:127], v[20:23]
  s_waitcnt vmcnt(13)
  v_mfma_f32_16x16x32_bf16 v[4:7], v[184:187], v[128:131], v[4:7]
  v_mfma_f32_16x16x32_bf16 v[8:11], v[188:191], v[128:131], v[8:11]
  v_mfma_f32_16x16x32_bf16 v[12:15], v[192:195], v[128:131], v[12:15]
  v_mfma_f32_16x16x32_bf16 v[16:19], v[196:199], v[128:131], v[16:19]
  v_mfma_f32_16x16x32_bf16 v[20:23], v[200:203], v[128:131], v[20:23]
  s_waitcnt vmcnt(12)
  v_mfma_f32_16x16x32_bf16 v[4:7], v[204:207], v[132:135], v[4:7]
  v_mfma_f32_16x16x32_bf16 v[8:11], v[208:211], v[132:135], v[8:11]
  v_mfma_f32_16x16x32_bf16 v[12:15], v[212:215], v[132:135], v[12:15]
  v_mfma_f32_16x16x32_bf16 v[16:19], v[216:219], v[132:135], v[16:19]
  v_mfma_f32_16x16x32_bf16 v[20:23], v[220:223], v[132:135], v[20:23]
  s_waitcnt vmcnt(11)
  v_mfma_f32_16x16x32_bf16 v[4:7], v[84:87], v[136:139], v[4:7]
  v_mfma_f32_16x16x32_bf16 v[8:11], v[88:91], v[136:139], v[8:11]
  v_mfma_f32_16x16x32_bf16 v[12:15], v[92:95], v[136:139], v[12:15]
  v_mfma_f32_16x16x32_bf16 v[16:19], v[96:99], v[136:139], v[16:19]
  v_mfma_f32_16x16x32_bf16 v[20:23], v[100:103], v[136:139], v[20:23]
  s_waitcnt vmcnt(10)
  v_mfma_f32_16x16x32_bf16 v[4:7], v[104:107], v[140:143], v[4:7]
  v_mfma_f32_16x16x32_bf16 v[8:11], v[108:111], v[140:143], v[8:11]
  v_mfma_f32_16x16x32_bf16 v[12:15], v[112:115], v[140:143], v[12:15]
  v_mfma_f32_16x16x32_bf16 v[16:19], v[116:119], v[140:143], v[16:19]
  v_mfma_f32_16x16x32_bf16 v[20:23], v[120:123], v[140:143], v[20:23]
  buffer_load_dwordx4 v[124:127], v1, s[16:19], s68 offen offset:3072 sc1
  buffer_load_dwordx4 v[128:131], v1, s[16:19], s69 offen offset:3072 sc1
  buffer_load_dwordx4 v[132:135], v1, s[16:19], s70 offen offset:3072 sc1
  buffer_load_dwordx4 v[136:139], v1, s[16:19], s71 offen offset:3072 sc1
  buffer_load_dwordx4 v[140:143], v1, s[16:19], s38 offen offset:3072 sc1
  s_lshl_b32 s3, s63, 2
  s_add_u32 s3, s3, 160288
  v_mov_b32 v254, s3
  s_mov_b32 s80, 4000000
Llw_16:
  ds_read_b32 v255, v254
  s_waitcnt lgkmcnt(0)
  v_cmp_ne_u32 vcc, 2, v255
  s_cbranch_vccz Llw_16_d
  s_sleep 1
  s_sub_u32 s80, s80, 1
  s_cbranch_scc0 Llw_16
Llw_16_d:
  s_waitcnt vmcnt(14)
  v_mfma_f32_16x16x32_bf16 v[24:27], v[164:167], v[144:147], v[24:27]
  v_mfma_f32_16x16x32_bf16 v[28:31], v[168:171], v[144:147], v[28:31]
  v_mfma_f32_16x16x32_bf16 v[32:35], v[172:175], v[144:147], v[32:35]
  v_mfma_f32_16x16x32_bf16 v[36:39], v[176:179], v[144:147], v[36:39]
  ds_write_b128 v249, v[4:7] offset:0
  v_mfma_f32_16x16x32_bf16 v[40:43], v[180:183], v[144:147], v[40:43]
  ds_write_b128 v249, v[8:11] offset:64
  s_waitcnt vmcnt(13)
  v_mfma_f32_16x16x32_bf16 v[24:27], v[184:187], v[148:151], v[24:27]
  ds_write_b128 v249, v[12:15] offset:128
  v_mfma_f32_16x16x32_bf16 v[28:31], v[188:191], v[148:151], v[28:31]
  ds_write_b128 v249, v[16:19] offset:192
  v_mfma_f32_16x16x32_bf16 v[32:35], v[192:195], v[148:151], v[32:35]
  ds_write_b128 v249, v[20:23] offset:256
  v_mfma_f32_16x16x32_bf16 v[36:39], v[196:199], v[148:151], v[36:39]
  v_mfma_f32_16x16x32_bf16 v[40:43], v[200:203], v[148:151], v[40:43]
  s_waitcnt vmcnt(12)
  v_mfma_f32_16x16x32_bf16 v[24:27], v[204:207], v[152:155], v[24:27]
  v_mfma_f32_16x16x32_bf16 v[28:31], v[208:211], v[152:155], v[28:31]
  v_mfma_f32_16x16x32_bf16 v[32:35], v[212:215], v[152:155], v[32:35]
  v_mfma_f32_16x16x32_bf16 v[36:39], v[216:219], v[152:155], v[36:39]
  v_mfma_f32_16x16x32_bf16 v[40:43], v[220:223], v[152:155], v[40:43]
  s_mov_b64 exec, 1
  s_waitcnt lgkmcnt(0)
  ds_add_u32 v252, v253 offset:0
  s_mov_b64 exec, -1
  s_waitcnt vmcnt(11)
  v_mfma_f32_16x16x32_bf16 v[24:27], v[84:87], v[156:159], v[24:27]
  v_mfma_f32_16x16x32_bf16 v[28:31], v[88:91], v[156:159], v[28:31]
  v_mfma_f32_16x16x32_bf16 v[32:35], v[92:95], v[156:159], v[32:35]
  v_mfma_f32_16x16x32_bf16 v[36:39], v[96:99], v[156:159], v[36:39]
  v_mfma_f32_16x16x32_bf16 v[40:43], v[100:103], v[156:159], v[40:43]
  s_waitcnt vmcnt(10)
  v_mfma_f32_16x16x32_bf16 v[24:27], v[104:107], v[160:163], v[24:27]
  v_mfma_f32_16x16x32_bf16 v[28:31], v[108:111], v[160:163], v[28:31]
  v_mfma_f32_16x16x32_bf16 v[32:35], v[112:115], v[160:163], v[32:35]
  v_mfma_f32_16x16x32_bf16 v[36:39], v[116:119], v[160:163], v[36:39]
  v_mfma_f32_16x16x32_bf16 v[40:43], v[120:123], v[160:163], v[40:43]
  s_waitcnt vmcnt(9)
  v_mfma_f32_16x16x32_bf16 v[44:47], v[164:167], v[224:227], v[44:47]
  v_mfma_f32_16x16x32_bf16 v[48:51], v[168:171], v[224:227], v[48:51]
  v_mfma_f32_16x16x32_bf16 v[52:55], v[172:175], v[224:227], v[52:55]
  v_mfma_f32_16x16x32_bf16 v[56:59], v[176:179], v[224:227], v[56:59]
  ds_write_b128 v249, v[24:27] offset:5120
  v_mfma_f32_16x16x32_bf16 v[60:63], v[180:183], v[224:227], v[60:63]
  ds_write_b128 v249, v[28:31] offset:5184
  s_waitcnt vmcnt(8)
  v_mfma_f32_16x16x32_bf16 v[44:47], v[184:187], v[228:231], v[44:47]
  ds_write_b128 v249, v[32:35] offset:5248
  v_mfma_f32_16x16x32_bf16 v[48:51], v[188:191], v[228:231], v[48:51]
  ds_write_b128 v249, v[36:39] offset:5312
  v_mfma_f32_16x16x32_bf16 v[52:55], v[192:195], v[228:231], v[52:55]
  ds_write_b128 v249, v[40:43] offset:5376
  v_mfma_f32_16x16x32_bf16 v[56:59], v[196:199], v[228:231], v[56:59]
  v_mfma_f32_16x16x32_bf16 v[60:63], v[200:203], v[228:231], v[60:63]
  s_waitcnt vmcnt(7)
  v_mfma_f32_16x16x32_bf16 v[44:47], v[204:207], v[232:235], v[44:47]
  v_mfma_f32_16x16x32_bf16 v[48:51], v[208:211], v[232:235], v[48:51]
  v_mfma_f32_16x16x32_bf16 v[52:55], v[212:215], v[232:235], v[52:55]
  v_mfma_f32_16x16x32_bf16 v[56:59], v[216:219], v[232:235], v[56:59]
  v_mfma_f32_16x16x32_bf16 v[60:63], v[220:223], v[232:235], v[60:63]
  s_mov_b64 exec, 1
  s_waitcnt lgkmcnt(0)
  ds_add_u32 v252, v253 offset:4
  s_mov_b64 exec, -1
  s_waitcnt vmcnt(6)
  v_mfma_f32_16x16x32_bf16 v[44:47], v[84:87], v[236:239], v[44:47]
  v_mfma_f32_16x16x32_bf16 v[48:51], v[88:91], v[236:239], v[48:51]
  v_mfma_f32_16x16x32_bf16 v[52:55], v[92:95], v[236:239], v[52:55]
  v_mfma_f32_16x16x32_bf16 v[56:59], v[96:99], v[236:239], v[56:59]
  v_mfma_f32_16x16x32_bf16 v[60:63], v[100:103], v[236:239], v[60:63]
  s_waitcnt vmcnt(5)
  v_mfma_f32_16x16x32_bf16 v[44:47], v[104:107], v[240:243], v[44:47]
  v_mfma_f32_16x16x32_bf16 v[48:51], v[108:111], v[240:243], v[48:51]
  v_mfma_f32_16x16x32_bf16 v[52:55], v[112:115], v[240:243], v[52:55]
  v_mfma_f32_16x16x32_bf16 v[56:59], v[116:119], v[240:243], v[56:59]
  v_mfma_f32_16x16x32_bf16 v[60:63], v[120:123], v[240:243], v[60:63]
  v_mov_b32 v254, 160268
  s_mov_b32 s80, 4000000
Llw_17:
  ds_read_b32 v255, v254
  s_waitcnt lgkmcnt(0)
  v_cmp_ne_u32 vcc, 4, v255
  s_cbranch_vccz Llw_17_d
  s_sleep 1
  s_sub_u32 s80, s80, 1
  s_cbranch_scc0 Llw_17
Llw_17_d:
  s_waitcnt vmcnt(4)
  v_mfma_f32_16x16x32_bf16 v[64:67], v[164:167], v[124:127], v[64:67]
  v_mfma_f32_16x16x32_bf16 v[68:71], v[168:171], v[124:127], v[68:71]
  v_mfma_f32_16x16x32_bf16 v[72:75], v[172:175], v[124:127], v[72:75]
  v_mfma_f32_16x16x32_bf16 v[76:79], v[176:179], v[124:127], v[76:79]
  ds_write_b128 v250, v[44:47] offset:0
  v_mfma_f32_16x16x32_bf16 v[80:83], v[180:183], v[124:127], v[80:83]
  ds_write_b128 v250, v[48:51] offset:64
  s_waitcnt vmcnt(3)
  v_mfma_f32_16x16x32_bf16 v[64:67], v[184:187], v[128:131], v[64:67]
  ds_write_b128 v250, v[52:55] offset:128
  v_mfma_f32_16x16x32_bf16 v[68:71], v[188:191], v[128:131], v[68:71]
  ds_write_b128 v250, v[56:59] offset:192
  v_mfma_f32_16x16x32_bf16 v[72:75], v[192:195], v[128:131], v[72:75]
  ds_write_b128 v250, v[60:63] offset:256
  v_mfma_f32_16x16x32_bf16 v[76:79], v[196:199], v[128:131], v[76:79]
  v_mfma_f32_16x16x32_bf16 v[80:83], v[200:203], v[128:131], v[80:83]
  s_waitcnt vmcnt(2)
  v_mfma_f32_16x16x32_bf16 v[64:67], v[204:207], v[132:135], v[64:67]
  v_mfma_f32_16x16x32_bf16 v[68:71], v[208:211], v[132:135], v[68:71]
  v_mfma_f32_16x16x32_bf16 v[72:75], v[212:215], v[132:135], v[72:75]
  v_mfma_f32_16x16x32_bf16 v[76:79], v[216:219], v[132:135], v[76:79]
  v_mfma_f32_16x16x32_bf16 v[80:83], v[220:223], v[132:135], v[80:83]
  s_mov_b64 exec, 1
  s_waitcnt lgkmcnt(0)
  ds_add_u32 v252, v253 offset:8
  s_mov_b64 exec, -1
  s_waitcnt vmcnt(1)
  v_mfma_f32_16x16x32_bf16 v[64:67], v[84:87], v[136:139], v[64:67]
  v_mfma_f32_16x16x32_bf16 v[68:71], v[88:91], v[136:139], v[68:71]
  v_mfma_f32_16x16x32_bf16 v[72:75], v[92:95], v[136:139], v[72:75]
  v_mfma_f32_16x16x32_bf16 v[76:79], v[96:99], v[136:139], v[76:79]
  v_mfma_f32_16x16x32_bf16 v[80:83], v[100:103], v[136:139], v[80:83]
  s_waitcnt vmcnt(0)
  v_mfma_f32_16x16x32_bf16 v[64:67], v[104:107], v[140:143], v[64:67]
  v_mfma_f32_16x16x32_bf16 v[68:71], v[108:111], v[140:143], v[68:71]
  v_mfma_f32_16x16x32_bf16 v[72:75], v[112:115], v[140:143], v[72:75]
  v_mfma_f32_16x16x32_bf16 v[76:79], v[116:119], v[140:143], v[76:79]
  v_mfma_f32_16x16x32_bf16 v[80:83], v[120:123], v[140:143], v[80:83]
  v_mov_b32 v254, 160264
  s_mov_b32 s80, 4000000
Llw_18:
  ds_read_b32 v255, v254
  s_waitcnt lgkmcnt(0)
  v_cmp_ne_u32 vcc, 8, v255
  s_cbranch_vccz Llw_18_d
  s_sleep 1
  s_sub_u32 s80, s80, 1
  s_cbranch_scc0 Llw_18
Llw_18_d:
  ds_write_b128 v251, v[64:67] offset:0
  ds_write_b128 v251, v[68:71] offset:64
  ds_write_b128 v251, v[72:75] offset:128
  ds_write_b128 v251, v[76:79] offset:192
  ds_write_b128 v251, v[80:83] offset:256
  s_mov_b64 exec, 1
  s_waitcnt lgkmcnt(0)
  ds_add_u32 v252, v253 offset:12
  s_mov_b64 exec, -1
  s_branch L_alldone
L_oslow:
  v_mfma_f32_16x16x32_bf16 v[4:7], v[144:147], v[240:243], v[4:7]
  v_mfma_f32_16x16x32_bf16 v[24:27], v[144:147], v[244:247], v[24:27]
  v_mfma_f32_16x16x32_bf16 v[44:47], v[144:147], v[248:251], v[44:47]
  v_mfma_f32_16x16x32_bf16 v[64:67], v[144:147], v[252:255], v[64:67]
  v_mfma_f32_16x16x32_bf16 v[8:11], v[148:151], v[240:243], v[8:11]
  v_mfma_f32_16x16x32_bf16 v[28:31], v[148:151], v[244:247], v[28:31]
  v_mfma_f32_16x16x32_bf16 v[48:51], v[148:151], v[248:251], v[48:51]
  v_mfma_f32_16x16x32_bf16 v[68:71], v[148:151], v[252:255], v[68:71]
  v_mfma_f32_16x16x32_bf16 v[12:15], v[152:155], v[240:243], v[12:15]
  v_mfma_f32_16x16x32_bf16 v[32:35], v[152:155], v[244:247], v[32:35]
  v_mfma_f32_16x16x32_bf16 v[52:55], v[152:155], v[248:251], v[52:55]
  v_mfma_f32_16x16x32_bf16 v[72:75], v[152:155], v[252:255], v[72:75]
  v_mfma_f32_16x16x32_bf16 v[16:19], v[156:159], v[240:243], v[16:19]
  v_mfma_f32_16x16x32_bf16 v[36:39], v[156:159], v[244:247], v[36:39]
  v_mfma_f32_16x16x32_bf16 v[56:59], v[156:159], v[248:251], v[56:59]
  v_mfma_f32_16x16x32_bf16 v[76:79], v[156:159], v[252:255], v[76:79]
  v_mfma_f32_16x16x32_bf16 v[20:23], v[160:163], v[240:243], v[20:23]
  v_mfma_f32_16x16x32_bf16 v[40:43], v[160:163], v[244:247], v[40:43]
  v_mfma_f32_16x16x32_bf16 v[60:63], v[160:163], v[248:251], v[60:63]
  v_mfma_f32_16x16x32_bf16 v[80:83], v[160:163], v[252:255], v[80:83]
L_oslow2:
  s_setprio 0
  v_lshlrev_b32 v3, 2, v0
  s_mov_b32 s80, 200000
  s_mov_b64 exec, 0xf
Lpoll_o_15:
  buffer_load_dword v248, v3, s[16:19], s77 offen sc1
  s_waitcnt vmcnt(0)
  v_cmp_ne_u32 vcc, s62, v248
  s_cbranch_vccz Lpoll_o_15_d
  s_sleep 2
  s_sub_u32 s80, s80, 1
  s_cbranch_scc0 Lpoll_o_15
Lpoll_o_15_d:
  s_mov_b64 exec, -1
  buffer_load_dwordx4 v[124:127], v1, s[16:19], s68 offen offset:0 sc1
  buffer_load_dwordx4 v[128:131], v1, s[16:19], s69 offen offset:0 sc1
  buffer_load_dwordx4 v[132:135], v1, s[16:19], s70 offen offset:0 sc1
  buffer_load_dwordx4 v[136:139], v1, s[16:19], s71 offen offset:0 sc1
  buffer_load_dwordx4 v[140:143], v1, s[16:19], s38 offen offset:0 sc1
  buffer_load_dwordx4 v[144:147], v1, s[16:19], s68 offen offset:1024 sc1
  buffer_load_dwordx4 v[148:151], v1, s[16:19], s69 offen offset:1024 sc1
  buffer_load_dwordx4 v[152:155], v1, s[16:19], s70 offen offset:1024 sc1
  buffer_load_dwordx4 v[156:159], v1, s[16:19], s71 offen offset:1024 sc1
  buffer_load_dwordx4 v[160:163], v1, s[16:19], s38 offen offset:1024 sc1
  buffer_load_dwordx4 v[224:227], v1, s[16:19], s68 offen offset:2048 sc1
  buffer_load_dwordx4 v[228:231], v1, s[16:19], s69 offen offset:2048 sc1
  buffer_load_dwordx4 v[232:235], v1, s[16:19], s70 offen offset:2048 sc1
  buffer_load_dwordx4 v[236:239], v1, s[16:19], s71 offen offset:2048 sc1
  buffer_load_dwordx4 v[240:243], v1, s[16:19], s38 offen offset:2048 sc1
  s_branch L_oback
L_compute:
  s_lshr_b32 s63, s61, 1
  s_and_b32 s64, s61, 1
  s_lshl_b32 s3, s60, 3
  s_add_u32 s3, s3, s59
  s_lshl_b32 s3, s3, 2
  s_add_u32 s3, s3, s61
  s_lshl_b32 s3, s3, 1
  s_lshl_b32 s65, s58, 7
  s_add_u32 s3, s3, s65
  s_mul_i32 s65, s3, 1280
  s_lshl_b32 s66, s3, 4
  s_add_u32 s66, s66, 0xd00000
  v_lshrrev_b32 v5, 5, v0
  v_and_b32 v6, 31, v0
  v_mul_u32_u24 v7, 1280, v5
  v_lshl_add_u32 v224, v6, 4, v7
  v_lshl_add_u32 v225, v6, 3, v7
  s_lshl_b32 s68, s61, 7
  s_lshl_b32 s3, s58, 3
  s_add_u32 s68, s68, s3
  s_add_u32 s68, s68, s59
  s_mov_b32 s69, s68
  s_movk_i32 s75, 680
  s_add_u32 s3, s68, 680
  s_add_u32 s83, s3, 1
  s_min_u32 s83, s83, 680
  s_cmp_eq_u32 s60, 0
  s_cselect_b32 s69, s3, s69
  s_cselect_b32 s75, s83, s75
  v_lshrrev_b32 v2, 3, v0
  v_and_b32 v4, 7, v0
  v_and_b32 v7, 6, v2
  v_xor_b32 v7, v4, v7
  v_lshlrev_b32 v4, 4, v7
  v_and_b32 v6, 3, v2
  s_lshl_b32 s3, s61, 12
  s_add_u32 m0, s3, 135552
  s_mov_b32 s11, 0x20000
  s_mov_b32 s83, s69
  s_mov_b32 s6, 0x280000
  s_mov_b32 s7, 0x20000
  s_waitcnt lgkmcnt(0)
  s_mov_b32 s4, s36
  s_mov_b32 s5, s37
  buffer_load_dwordx4 v[124:127], v224, s[4:7], s65 offen
  buffer_load_dwordx4 v[128:131], v224, s[4:7], s65 offen offset:512
  buffer_load_dwordx2 v[132:133], v225, s[4:7], s65 offen offset:1024
  s_add_u32 s78, s56, 0xd10000
  s_addc_u32 s79, s57, 0
  s_load_dword s62, s[78:79], 0
  v_mov_b32 v193, v5
  v_mov_b32 v194, v6
  v_mov_b32 v197, v4
  s_mov_b32 s28, s46
  s_mov_b32 s29, s47
  s_mov_b32 s30, 0xc00
  s_mov_b32 s31, 0x20000
  s_mov_b32 s16, s56
  s_mov_b32 s17, s57
  s_mov_b32 s18, 0x1000000
  s_mov_b32 s19, 0x20000
  s_mov_b32 s24, s52
  s_mov_b32 s25, s53
  s_mov_b32 s26, 0x280000
  s_mov_b32 s27, 0x20000
  s_mov_b32 s32, s50
  s_mov_b32 s33, s51
  s_mov_b32 s34, 0x500
  s_mov_b32 s35, 0x20000
  v_and_b32 v2, 15, v0
  v_lshrrev_b32 v3, 4, v0
  v_lshrrev_b32 v4, 1, v2
  v_xor_b32 v4, v4, v3
  v_lshlrev_b32 v4, 4, v4
  v_lshl_add_u32 v4, v2, 7, v4
  v_lshlrev_b32 v1, 3, v3
  s_lshl_b32 s3, s63, 13
  v_add_u32 v208, s3, v4
  v_xor_b32 v209, 64, v208
  v_lshlrev_b32 v226, 2, v2
  v_add_u32 v226, 160256, v226
  v_lshrrev_b32 v2, 2, v0
  v_and_b32 v3, 3, v0
  v_mul_u32_u24 v4, 160, v2
  s_mul_i32 s3, s64, 80
  v_add_u32 v4, s3, v4
  v_lshl_add_u32 v210, v3, 3, v4
  v_and_b32 v5, 1, v3
  v_lshl_add_u32 v4, v5, 3, v4
  v_add_u32 v4, 16448, v4
  s_cmp_eq_u32 s60, 0
  s_cselect_b32 s3, 10192, 0
  v_lshrrev_b32 v5, 1, v3
  v_mad_u32_u24 v211, v5, s3, v4
  v_lshlrev_b32 v4, 7, v2
  v_lshl_add_u32 v4, v3, 3, v4
  v_bfe_u32 v5, v0, 3, 2
  v_lshl_add_u32 v4, v5, 5, v4
  s_lshl_b32 s3, s61, 12
  s_add_u32 s3, s3, 135552
  v_add_u32 v200, s3, v4
  s_lshl_b32 s3, s64, 6
  s_cmp_eq_u32 s60, 0
  s_cselect_b32 s3, s3, 0
  v_xor_b32 v4, s3, v4
  s_lshl_b32 s3, s64, 13
  s_add_u32 s3, s3, 26624
  s_cmp_eq_u32 s60, 0
  s_cselect_b32 s3, 36992, s3
  v_xor_b32 v5, 0, v4
  v_add_u32 v212, s3, v5
  v_xor_b32 v5, 32, v4
  v_add_u32 v213, s3, v5
  v_xor_b32 v5, 64, v4
  v_add_u32 v214, s3, v5
  v_xor_b32 v5, 96, v4
  v_add_u32 v215, s3, v5
  s_lshl_b32 s3, s64, 6
  s_lshl_b32 s3, s3, s60
  s_lshl_b32 s72, s60, 7
  s_add_u32 s3, s3, s72
  s_mul_i32 s72, s59, 384
  s_add_u32 s72, s3, s72
  buffer_load_dwordx2 v[216:217], v1, s[28:31], s72 offen offset:0
  buffer_load_dwordx2 v[218:219], v1, s[28:31], s72 offen offset:32
  buffer_load_dwordx2 v[220:221], v1, s[28:31], s72 offen offset:64
  buffer_load_dwordx2 v[222:223], v1, s[28:31], s72 offen offset:96
  v_mov_b64 v[8:9], 0
  v_mov_b64 v[10:11], 0
  v_mov_b64 v[12:13], 0
  v_mov_b64 v[14:15], 0
  v_mov_b64 v[16:17], 0
  v_mov_b64 v[18:19], 0
  v_mov_b64 v[20:21], 0
  v_mov_b64 v[22:23], 0
  v_mov_b64 v[24:25], 0
  v_mov_b64 v[26:27], 0
  v_mov_b64 v[28:29], 0
  v_mov_b64 v[30:31], 0
  v_mov_b64 v[32:33], 0
  v_mov_b64 v[34:35], 0
  v_mov_b64 v[36:37], 0
  v_mov_b64 v[38:39], 0
  v_mov_b64 v[40:41], 0
  v_mov_b64 v[42:43], 0
  v_mov_b64 v[44:45], 0
  v_mov_b64 v[46:47], 0
  v_mov_b64 v[48:49], 0
  v_mov_b64 v[50:51], 0
  v_mov_b64 v[52:53], 0
  v_mov_b64 v[54:55], 0
  v_mov_b64 v[56:57], 0
  v_mov_b64 v[58:59], 0
  v_mov_b64 v[60:61], 0
  v_mov_b64 v[62:63], 0
  v_mov_b64 v[64:65], 0
  v_mov_b64 v[66:67], 0
  v_mov_b64 v[68:69], 0
  v_mov_b64 v[70:71], 0
  v_mov_b64 v[72:73], 0
  v_mov_b64 v[74:75], 0
  v_mov_b64 v[76:77], 0
  v_mov_b64 v[78:79], 0
  v_mov_b64 v[80:81], 0
  v_mov_b64 v[82:83], 0
  v_mov_b64 v[84:85], 0
  v_mov_b64 v[86:87], 0
  v_mov_b64 v[88:89], 0
  v_mov_b64 v[90:91], 0
  v_mov_b64 v[92:93], 0
  v_mov_b64 v[94:95], 0
  v_mov_b64 v[96:97], 0
  v_mov_b64 v[98:99], 0
  v_mov_b64 v[100:101], 0
  v_mov_b64 v[102:103], 0
  v_mov_b64 v[104:105], 0
  v_mov_b64 v[106:107], 0
  v_mov_b64 v[108:109], 0
  v_mov_b64 v[110:111], 0
  v_mov_b64 v[112:113], 0
  v_mov_b64 v[114:115], 0
  v_mov_b64 v[116:117], 0
  v_mov_b64 v[118:119], 0
  s_waitcnt lgkmcnt(0)
  s_and_b32 s3, s62, 0x7f7f7f7f
  s_add_u32 s3, s3, 0x35251513
  s_and_b32 s62, s62, 0x80808080
  s_xor_b32 s62, s62, s3
  v_mov_b32 v6, 0
  v_mov_b32 v7, s62
  ds_write2_b32 v226, v6, v7 offset0:0 offset1:16
  s_waitcnt vmcnt(4)
  v_lshlrev_b32 v136, 16, v124
  v_and_b32 v137, 0xffff0000, v124
  v_lshlrev_b32 v138, 16, v125
  v_and_b32 v139, 0xffff0000, v125
  v_lshlrev_b32 v140, 16, v126
  v_and_b32 v141, 0xffff0000, v126
  v_lshlrev_b32 v142, 16, v127
  v_and_b32 v143, 0xffff0000, v127
  v_lshlrev_b32 v144, 16, v128
  v_and_b32 v145, 0xffff0000, v128
  v_lshlrev_b32 v146, 16, v129
  v_and_b32 v147, 0xffff0000, v129
  v_lshlrev_b32 v148, 16, v130
  v_and_b32 v149, 0xffff0000, v130
  v_lshlrev_b32 v150, 16, v131
  v_and_b32 v151, 0xffff0000, v131
  v_lshlrev_b32 v152, 16, v132
  v_and_b32 v153, 0xffff0000, v132
  v_lshlrev_b32 v154, 16, v133
  v_and_b32 v155, 0xffff0000, v133
  v_pk_add_f32 v[2:3], v[136:137], v[138:139]
  v_pk_add_f32 v[4:5], v[140:141], v[142:143]
  v_pk_add_f32 v[2:3], v[2:3], v[144:145]
  v_pk_add_f32 v[4:5], v[4:5], v[146:147]
  v_pk_add_f32 v[2:3], v[2:3], v[148:149]
  v_pk_add_f32 v[4:5], v[4:5], v[150:151]
  v_pk_add_f32 v[2:3], v[2:3], v[152:153]
  v_pk_add_f32 v[4:5], v[4:5], v[154:155]
  v_pk_add_f32 v[2:3], v[2:3], v[4:5]
  v_add_f32 v2, v2, v3
  s_nop 1
  v_add_f32_dpp v2, v2, v2 quad_perm:[1,0,3,2] row_mask:0xf bank_mask:0xf
  s_nop 1
  v_add_f32_dpp v2, v2, v2 quad_perm:[2,3,0,1] row_mask:0xf bank_mask:0xf
  s_nop 1
  v_add_f32_dpp v2, v2, v2 row_half_mirror row_mask:0xf bank_mask:0xf
  s_nop 1
  v_add_f32_dpp v2, v2, v2 row_mirror row_mask:0xf bank_mask:0xf
  v_mov_b32 v3, v2
  s_nop 1
  v_permlane16_swap_b32 v2, v3
  s_nop 1
  v_add_f32 v2, v2, v3
  v_mul_f32 v2, 0x3acccccd, v2
  v_pk_add_f32 v[136:137], v[136:137], v[2:3] op_sel_hi:[1,0] neg_lo:[0,1] neg_hi:[0,1]
  v_pk_add_f32 v[138:139], v[138:139], v[2:3] op_sel_hi:[1,0] neg_lo:[0,1] neg_hi:[0,1]
  v_pk_add_f32 v[140:141], v[140:141], v[2:3] op_sel_hi:[1,0] neg_lo:[0,1] neg_hi:[0,1]
  v_pk_add_f32 v[142:143], v[142:143], v[2:3] op_sel_hi:[1,0] neg_lo:[0,1] neg_hi:[0,1]
  v_pk_add_f32 v[144:145], v[144:145], v[2:3] op_sel_hi:[1,0] neg_lo:[0,1] neg_hi:[0,1]
  v_pk_add_f32 v[146:147], v[146:147], v[2:3] op_sel_hi:[1,0] neg_lo:[0,1] neg_hi:[0,1]
  v_pk_add_f32 v[148:149], v[148:149], v[2:3] op_sel_hi:[1,0] neg_lo:[0,1] neg_hi:[0,1]
  v_pk_add_f32 v[150:151], v[150:151], v[2:3] op_sel_hi:[1,0] neg_lo:[0,1] neg_hi:[0,1]
  v_pk_add_f32 v[152:153], v[152:153], v[2:3] op_sel_hi:[1,0] neg_lo:[0,1] neg_hi:[0,1]
  v_pk_add_f32 v[154:155], v[154:155], v[2:3] op_sel_hi:[1,0] neg_lo:[0,1] neg_hi:[0,1]
  v_pk_mul_f32 v[4:5], v[136:137], v[136:137]
  v_pk_mul_f32 v[6:7], v[138:139], v[138:139]
  v_pk_fma_f32 v[4:5], v[140:141], v[140:141], v[4:5]
  v_pk_fma_f32 v[6:7], v[142:143], v[142:143], v[6:7]
  v_pk_fma_f32 v[4:5], v[144:145], v[144:145], v[4:5]
  v_pk_fma_f32 v[6:7], v[146:147], v[146:147], v[6:7]
  v_pk_fma_f32 v[4:5], v[148:149], v[148:149], v[4:5]
  v_pk_fma_f32 v[6:7], v[150:151], v[150:151], v[6:7]
  v_pk_fma_f32 v[4:5], v[152:153], v[152:153], v[4:5]
  v_pk_fma_f32 v[6:7], v[154:155], v[154:155], v[6:7]
  v_pk_add_f32 v[4:5], v[4:5], v[6:7]
  v_add_f32 v4, v4, v5
  s_nop 1
  v_add_f32_dpp v4, v4, v4 quad_perm:[1,0,3,2] row_mask:0xf bank_mask:0xf
  s_nop 1
  v_add_f32_dpp v4, v4, v4 quad_perm:[2,3,0,1] row_mask:0xf bank_mask:0xf
  s_nop 1
  v_add_f32_dpp v4, v4, v4 row_half_mirror row_mask:0xf bank_mask:0xf
  s_nop 1
  v_add_f32_dpp v4, v4, v4 row_mirror row_mask:0xf bank_mask:0xf
  v_mov_b32 v5, v4
  s_nop 1
  v_permlane16_swap_b32 v4, v5
  s_nop 1
  v_add_f32 v4, v4, v5
  v_mul_f32 v4, 0x3acccccd, v4
  v_cvt_pk_bf16_f32 v4, v4, v4
  v_lshlrev_b32 v4, 16, v4
  v_add_f32 v4, 0x3727c5ac, v4
  v_cvt_pk_bf16_f32 v4, v4, v4
  v_lshlrev_b32 v4, 16, v4
  v_sqrt_f32 v4, v4
  s_nop 0
  v_cvt_pk_bf16_f32 v4, v4, v4
  v_lshlrev_b32 v4, 16, v4
  v_cvt_pk_bf16_f32 v2, v2, v2
  v_lshlrev_b32 v2, 16, v2
  v_rcp_f32 v232, v4
  v_mov_b32 v233, s62
  v_mov_b32 v235, s62
  v_mul_f32 v234, v232, v2
  v_lshrrev_b32 v5, 1, v0
  s_mov_b32 exec_lo, 1
  s_mov_b32 exec_hi, 1
  buffer_store_dwordx4 v[232:235], v5, s[16:19], s66 offen sc1
  s_mov_b64 exec, -1
  s_and_b32 s3, s2, 7
  s_cmp_lt_u32 s3, 5
  s_cselect_b32 s73, 1, 0
  s_cbranch_scc0 L_nosel
  s_lshl_b32 s3, s3, 1
  s_and_b32 s73, s58, 1
  s_add_u32 s3, s3, s73
  s_lshl_b32 s73, s60, 3
  s_add_u32 s73, s73, s59
  s_mul_i32 s73, s73, 10
  s_add_u32 s3, s3, s73
  s_lshl_b32 s3, s3, 10
  s_mul_i32 s73, s64, 448
  s_add_u32 s3, s3, s73
  s_lshl_b32 s73, s63, 8
  s_add_u32 s3, s3, s73
  s_add_u32 s73, s3, 0xd20000
  v_and_b32 v6, 15, v0
  v_mov_b32 v7, 0x3f803f80
  v_and_b32 v4, 48, v0
  v_lshl_add_u32 v4, v6, 6, v4
  v_mov_b32 v5, 0xff
  v_cmp_eq_u32 vcc, 0, v6
  s_lshr_b32 s40, s62, 0
  s_nop 0
  v_cndmask_b32 v236, 0, v7, vcc
  v_cndmask_b32 v237, 0, v7, vcc
  v_mov_b64 v[238:239], v[236:237]
  v_cmp_eq_u32 vcc, 1, v6
  s_lshr_b32 s41, s62, 8
  s_nop 0
  v_cndmask_b32 v240, 0, v7, vcc
  v_cndmask_b32 v241, 0, v7, vcc
  v_mov_b64 v[242:243], v[240:241]
  v_cmp_eq_u32 vcc, 2, v6
  s_lshr_b32 s48, s62, 16
  s_nop 0
  v_cndmask_b32 v244, 0, v7, vcc
  v_cndmask_b32 v245, 0, v7, vcc
  v_mov_b64 v[246:247], v[244:245]
  v_cmp_eq_u32 vcc, 3, v6
  s_lshr_b32 s49, s62, 24
  s_nop 0
  v_cndmask_b32 v248, 0, v7, vcc
  v_cndmask_b32 v249, 0, v7, vcc
  v_mov_b64 v[250:251], v[248:249]
L_nosel:
  v_lshlrev_b32 v1, 4, v0
  v_mov_b32 v2, v200
  v_xor_b32 v3, 32, v200
  v_xor_b32 v6, 64, v200
  v_xor_b32 v7, 0x60, v200
  s_add_u32 s3, s69, 0
  s_lshl_b32 s83, s3, 12
  s_add_u32 s83, s83, 0x900000
  s_cmp_lt_u32 s3, s75
  s_cselect_b32 s83, s83, 0x7f000000
  s_add_u32 s3, s69, 512
  s_lshl_b32 s84, s3, 12
  s_add_u32 s84, s84, 0x900000
  s_cmp_lt_u32 s3, s75
  s_cselect_b32 s84, s84, 0x7f000000
  s_cmp_lg_u32 s60, 0
  s_cbranch_scc1 L_cqh
  s_mov_b32 s77, 0
  s_mov_b32 s76, 0
  s_waitcnt lgkmcnt(0)
  s_barrier
  ds_read_b128 v[120:123], v208 offset:0
  ds_read_b128 v[124:127], v208 offset:2048
  ds_read_b128 v[128:131], v208 offset:4096
  ds_read_b128 v[132:135], v208 offset:6144
  ds_read_b64_tr_b16 v[136:137], v210 offset:16384
  ds_read_b64_tr_b16 v[138:139], v210 offset:18944
  ds_read_b64_tr_b16 v[140:141], v210 offset:16416
  ds_read_b64_tr_b16 v[142:143], v210 offset:18976
  ds_read_b64_tr_b16 v[144:145], v211 offset:0
  ds_read_b64_tr_b16 v[146:147], v211 offset:2560
  ds_read_b64_tr_b16 v[148:149], v210 offset:26656
  ds_read_b64_tr_b16 v[150:151], v210 offset:29216
  ds_read_b64_tr_b16 v[152:153], v210 offset:26688
  ds_read_b64_tr_b16 v[154:155], v210 offset:29248
  ds_read_b64_tr_b16 v[156:157], v212 offset:0
  ds_read_b64_tr_b16 v[158:159], v212 offset:2048
  ds_read_b64_tr_b16 v[160:161], v213 offset:0
  ds_read_b64_tr_b16 v[162:163], v213 offset:2048
  s_cmp_eq_u32 s73, 0
  s_cbranch_scc1 L_ent0
  s_cmp_lg_u32 s63, 0
  s_cbranch_scc1 L_cs10
  ds_read_b64_tr_b16 v[180:181], v210 offset:21504
  ds_read_b64_tr_b16 v[182:183], v210 offset:24064
  ds_read_b64_tr_b16 v[184:185], v210 offset:21536
  ds_read_b64_tr_b16 v[186:187], v210 offset:24096
  ds_read_b64_tr_b16 v[188:189], v211 offset:5120
  ds_read_b64_tr_b16 v[190:191], v211 offset:7680
  ds_read_b64_tr_b16 v[192:193], v210 offset:31776
  ds_read_b64_tr_b16 v[194:195], v210 offset:34336
  s_waitcnt lgkmcnt(8)
  v_mfma_f32_16x16x32_bf16 v[252:255], v[136:139], v[236:239], 0
  v_mfma_f32_16x16x32_bf16 v[252:255], v[140:143], v[240:243], v[252:255]
  v_mfma_f32_16x16x32_bf16 v[252:255], v[144:147], v[244:247], v[252:255]
  v_mfma_f32_16x16x32_bf16 v[252:255], v[148:151], v[248:251], v[252:255]
  s_waitcnt lgkmcnt(0)
  v_mfma_f32_16x16x32_bf16 v[252:255], v[180:183], v[236:239], v[252:255]
  v_mfma_f32_16x16x32_bf16 v[252:255], v[184:187], v[240:243], v[252:255]
  v_mfma_f32_16x16x32_bf16 v[252:255], v[188:191], v[244:247], v[252:255]
  v_mfma_f32_16x16x32_bf16 v[252:255], v[192:195], v[248:251], v[252:255]
  s_mov_b32 s3, 0xf000f
  s_branch L_cs20
L_cs10:
  ds_read_b64_tr_b16 v[196:197], v210 offset:31808
  ds_read_b64_tr_b16 v[198:199], v210 offset:34368
  ds_read_b64_tr_b16 v[200:201], v212 offset:4096
  ds_read_b64_tr_b16 v[202:203], v212 offset:6144
  ds_read_b64_tr_b16 v[204:205], v213 offset:4096
  ds_read_b64_tr_b16 v[206:207], v213 offset:6144
  s_waitcnt lgkmcnt(6)
  v_mfma_f32_16x16x32_bf16 v[252:255], v[152:155], v[236:239], 0
  v_mfma_f32_16x16x32_bf16 v[252:255], v[156:159], v[240:243], v[252:255]
  v_mfma_f32_16x16x32_bf16 v[252:255], v[160:163], v[244:247], v[252:255]
  s_waitcnt lgkmcnt(0)
  v_mfma_f32_16x16x32_bf16 v[252:255], v[196:199], v[236:239], v[252:255]
  v_mfma_f32_16x16x32_bf16 v[252:255], v[200:203], v[240:243], v[252:255]
  v_mfma_f32_16x16x32_bf16 v[252:255], v[204:207], v[244:247], v[252:255]
  s_mov_b32 s3, 0x70007
L_cs20:
  s_nop 6
  v_bfi_b32 v252, v5, s40, v252
  v_bfi_b32 v253, v5, s41, v253
  v_bfi_b32 v254, v5, s48, v254
  v_bfi_b32 v255, v5, s49, v255
  s_mov_b32 exec_lo, s3
  s_mov_b32 exec_hi, s3
  buffer_store_dwordx4 v[252:255], v4, s[16:19], s73 offen sc1
  s_mov_b64 exec, -1
L_ent0:
  s_waitcnt lgkmcnt(0)
  s_branch L_mid0
.p2align 3
L_top0:
  s_barrier
  s_nop 0
  v_mfma_f32_16x16x32_bf16 v[8:11], v[164:167], v[180:183], v[8:11]
  ds_read_b128 v[120:123], v208 offset:0
  v_mfma_f32_16x16x32_bf16 v[36:39], v[168:171], v[180:183], v[36:39]
  ds_read_b128 v[124:127], v208 offset:2048
  v_mfma_f32_16x16x32_bf16 v[64:67], v[172:175], v[180:183], v[64:67]
  ds_read_b128 v[128:131], v208 offset:4096
  v_mfma_f32_16x16x32_bf16 v[92:95], v[176:179], v[180:183], v[92:95]
  ds_read_b128 v[132:135], v208 offset:6144
  v_mfma_f32_16x16x32_bf16 v[12:15], v[164:167], v[184:187], v[12:15]
  ds_read_b64_tr_b16 v[136:137], v210 offset:16384
  v_mfma_f32_16x16x32_bf16 v[40:43], v[168:171], v[184:187], v[40:43]
  ds_read_b64_tr_b16 v[138:139], v210 offset:18944
  v_mfma_f32_16x16x32_bf16 v[68:71], v[172:175], v[184:187], v[68:71]
  ds_read_b64_tr_b16 v[140:141], v210 offset:16416
  v_mfma_f32_16x16x32_bf16 v[96:99], v[176:179], v[184:187], v[96:99]
  ds_read_b64_tr_b16 v[142:143], v210 offset:18976
  v_mfma_f32_16x16x32_bf16 v[16:19], v[164:167], v[188:191], v[16:19]
  ds_read_b64_tr_b16 v[144:145], v211 offset:0
  v_mfma_f32_16x16x32_bf16 v[44:47], v[168:171], v[188:191], v[44:47]
  ds_read_b64_tr_b16 v[146:147], v211 offset:2560
  v_mfma_f32_16x16x32_bf16 v[72:75], v[172:175], v[188:191], v[72:75]
  ds_read_b64_tr_b16 v[148:149], v210 offset:26656
  v_mfma_f32_16x16x32_bf16 v[100:103], v[176:179], v[188:191], v[100:103]
  ds_read_b64_tr_b16 v[150:151], v210 offset:29216
  v_mfma_f32_16x16x32_bf16 v[20:23], v[164:167], v[192:195], v[20:23]
  ds_read_b64_tr_b16 v[152:153], v210 offset:26688
  v_mfma_f32_16x16x32_bf16 v[48:51], v[168:171], v[192:195], v[48:51]
  ds_read_b64_tr_b16 v[154:155], v210 offset:29248
  v_mfma_f32_16x16x32_bf16 v[76:79], v[172:175], v[192:195], v[76:79]
  ds_read_b64_tr_b16 v[156:157], v212 offset:0
  v_mfma_f32_16x16x32_bf16 v[104:107], v[176:179], v[192:195], v[104:107]
  ds_read_b64_tr_b16 v[158:159], v212 offset:2048
  v_mfma_f32_16x16x32_bf16 v[24:27], v[164:167], v[196:199], v[24:27]
  ds_read_b64_tr_b16 v[160:161], v213 offset:0
  v_mfma_f32_16x16x32_bf16 v[52:55], v[168:171], v[196:199], v[52:55]
  ds_read_b64_tr_b16 v[162:163], v213 offset:2048
  v_mfma_f32_16x16x32_bf16 v[80:83], v[172:175], v[196:199], v[80:83]
  v_mfma_f32_16x16x32_bf16 v[108:111], v[176:179], v[196:199], v[108:111]
  v_mfma_f32_16x16x32_bf16 v[28:31], v[200:203], v[164:167], v[28:31]
  v_mfma_f32_16x16x32_bf16 v[56:59], v[200:203], v[168:171], v[56:59]
  v_mfma_f32_16x16x32_bf16 v[84:87], v[200:203], v[172:175], v[84:87]
  v_mfma_f32_16x16x32_bf16 v[112:115], v[200:203], v[176:179], v[112:115]
  v_mfma_f32_16x16x32_bf16 v[32:35], v[204:207], v[164:167], v[32:35]
  v_mfma_f32_16x16x32_bf16 v[60:63], v[204:207], v[168:171], v[60:63]
  v_mfma_f32_16x16x32_bf16 v[88:91], v[204:207], v[172:175], v[88:91]
  v_mfma_f32_16x16x32_bf16 v[116:119], v[204:207], v[176:179], v[116:119]
  s_waitcnt lgkmcnt(0)
  s_nop 0
L_mid0:
  v_mfma_f32_16x16x32_bf16 v[8:11], v[120:123], v[136:139], v[8:11]
  ds_read_b128 v[164:167], v209 offset:0
  v_mfma_f32_16x16x32_bf16 v[36:39], v[124:127], v[136:139], v[36:39]
  ds_read_b128 v[168:171], v209 offset:2048
  v_mfma_f32_16x16x32_bf16 v[64:67], v[128:131], v[136:139], v[64:67]
  ds_read_b128 v[172:175], v209 offset:4096
  v_mfma_f32_16x16x32_bf16 v[92:95], v[132:135], v[136:139], v[92:95]
  ds_read_b128 v[176:179], v209 offset:6144
  v_mfma_f32_16x16x32_bf16 v[12:15], v[120:123], v[140:143], v[12:15]
  ds_read_b64_tr_b16 v[180:181], v210 offset:21504
  v_mfma_f32_16x16x32_bf16 v[40:43], v[124:127], v[140:143], v[40:43]
  ds_read_b64_tr_b16 v[182:183], v210 offset:24064
  v_mfma_f32_16x16x32_bf16 v[68:71], v[128:131], v[140:143], v[68:71]
  ds_read_b64_tr_b16 v[184:185], v210 offset:21536
  v_mfma_f32_16x16x32_bf16 v[96:99], v[132:135], v[140:143], v[96:99]
  ds_read_b64_tr_b16 v[186:187], v210 offset:24096
  v_mfma_f32_16x16x32_bf16 v[16:19], v[120:123], v[144:147], v[16:19]
  ds_read_b64_tr_b16 v[188:189], v211 offset:5120
  v_mfma_f32_16x16x32_bf16 v[44:47], v[124:127], v[144:147], v[44:47]
  ds_read_b64_tr_b16 v[190:191], v211 offset:7680
  v_mfma_f32_16x16x32_bf16 v[72:75], v[128:131], v[144:147], v[72:75]
  ds_read_b64_tr_b16 v[192:193], v210 offset:31776
  v_mfma_f32_16x16x32_bf16 v[100:103], v[132:135], v[144:147], v[100:103]
  ds_read_b64_tr_b16 v[194:195], v210 offset:34336
  v_mfma_f32_16x16x32_bf16 v[20:23], v[120:123], v[148:151], v[20:23]
  ds_read_b64_tr_b16 v[196:197], v210 offset:31808
  v_mfma_f32_16x16x32_bf16 v[48:51], v[124:127], v[148:151], v[48:51]
  ds_read_b64_tr_b16 v[198:199], v210 offset:34368
  v_mfma_f32_16x16x32_bf16 v[76:79], v[128:131], v[148:151], v[76:79]
  ds_read_b64_tr_b16 v[200:201], v212 offset:4096
  v_mfma_f32_16x16x32_bf16 v[104:107], v[132:135], v[148:151], v[104:107]
  ds_read_b64_tr_b16 v[202:203], v212 offset:6144
  v_mfma_f32_16x16x32_bf16 v[24:27], v[120:123], v[152:155], v[24:27]
  ds_read_b64_tr_b16 v[204:205], v213 offset:4096
  v_mfma_f32_16x16x32_bf16 v[52:55], v[124:127], v[152:155], v[52:55]
  ds_read_b64_tr_b16 v[206:207], v213 offset:6144
  v_mfma_f32_16x16x32_bf16 v[80:83], v[128:131], v[152:155], v[80:83]
  s_add_u32 s76, s76, 1
  s_cmp_eq_u32 s76, 3
  s_cselect_b32 s76, 0, s76
  s_mov_b32 s65, 45184
  s_cselect_b32 s65, 4294876928, s65
  s_add_u32 s77, s77, 1
  v_mfma_f32_16x16x32_bf16 v[108:111], v[132:135], v[152:155], v[108:111]
  v_add_u32_e64 v208, s65, v208
  v_mfma_f32_16x16x32_bf16 v[28:31], v[156:159], v[120:123], v[28:31]
  v_add_u32_e64 v209, s65, v209
  v_mfma_f32_16x16x32_bf16 v[56:59], v[156:159], v[124:127], v[56:59]
  v_add_u32_e64 v210, s65, v210
  v_mfma_f32_16x16x32_bf16 v[84:87], v[156:159], v[128:131], v[84:87]
  v_add_u32_e64 v211, s65, v211
  v_mfma_f32_16x16x32_bf16 v[112:115], v[156:159], v[132:135], v[112:115]
  v_add_u32_e64 v212, s65, v212
  v_mfma_f32_16x16x32_bf16 v[32:35], v[160:163], v[120:123], v[32:35]
  v_add_u32_e64 v213, s65, v213
  v_mfma_f32_16x16x32_bf16 v[60:63], v[160:163], v[124:127], v[60:63]
  v_mfma_f32_16x16x32_bf16 v[88:91], v[160:163], v[128:131], v[88:91]
  v_mfma_f32_16x16x32_bf16 v[116:119], v[160:163], v[132:135], v[116:119]
  s_cmp_lt_u32 s77, 10
  s_waitcnt lgkmcnt(0)
  s_cbranch_scc1 L_top0
  s_barrier
  v_mfma_f32_16x16x32_bf16 v[8:11], v[164:167], v[180:183], v[8:11]
  v_and_b32 v4, 15, v0
  v_lshlrev_b32 v4, 2, v4
  v_mfma_f32_16x16x32_bf16 v[12:15], v[164:167], v[184:187], v[12:15]
  s_lshl_b32 s3, s63, 8
  s_add_u32 s3, s3, 160768
  v_mfma_f32_16x16x32_bf16 v[16:19], v[164:167], v[188:191], v[16:19]
  v_add_u32 v5, s3, v4
  v_and_b32 v6, 48, v0
  v_mfma_f32_16x16x32_bf16 v[20:23], v[164:167], v[192:195], v[20:23]
  v_add_u32 v3, s3, v6
  s_mul_i32 s3, s64, 448
  v_mfma_f32_16x16x32_bf16 v[24:27], v[164:167], v[196:199], v[24:27]
  s_add_u32 s3, s3, 161792
  v_add_u32 v6, s3, v6
  v_mfma_f32_16x16x32_bf16 v[36:39], v[168:171], v[180:183], v[36:39]
  v_add_u32 v4, s3, v4
  v_mov_b32 v7, 160384
  v_mfma_f32_16x16x32_bf16 v[40:43], v[168:171], v[184:187], v[40:43]
  ds_read_b128 v[224:227], v3 offset:0
  ds_read_b128 v[240:243], v3 offset:512
  v_mfma_f32_16x16x32_bf16 v[44:47], v[168:171], v[188:191], v[44:47]
  ds_read_b128 v[228:231], v3 offset:64
  ds_read_b128 v[244:247], v3 offset:576
  v_mfma_f32_16x16x32_bf16 v[48:51], v[168:171], v[192:195], v[48:51]
  ds_read_b128 v[232:235], v3 offset:128
  ds_read_b128 v[248:251], v3 offset:640
  v_mfma_f32_16x16x32_bf16 v[52:55], v[168:171], v[196:199], v[52:55]
  ds_read_b128 v[236:239], v3 offset:192
  ds_read_b128 v[252:255], v3 offset:704
  v_mfma_f32_16x16x32_bf16 v[64:67], v[172:175], v[180:183], v[64:67]
  ds_read_b32 v120, v4 offset:0
  ds_read_b32 v124, v4 offset:64
  v_mfma_f32_16x16x32_bf16 v[68:71], v[172:175], v[184:187], v[68:71]
  ds_read_b32 v128, v4 offset:128
  ds_read_b32 v132, v4 offset:192
  v_mfma_f32_16x16x32_bf16 v[72:75], v[172:175], v[188:191], v[72:75]
  ds_read_b32 v136, v4 offset:256
  ds_read_b128 v[140:143], v6 offset:320
  v_mfma_f32_16x16x32_bf16 v[76:79], v[172:175], v[192:195], v[76:79]
  ds_read_b128 v[144:147], v6 offset:384
  ds_read2_b32 v[148:149], v5 offset0:0 offset1:128
  v_mfma_f32_16x16x32_bf16 v[80:83], v[172:175], v[196:199], v[80:83]
  ds_read2_b32 v[150:151], v5 offset0:16 offset1:144
  ds_read2_b32 v[152:153], v5 offset0:32 offset1:160
  v_mfma_f32_16x16x32_bf16 v[92:95], v[176:179], v[180:183], v[92:95]
  ds_read2_b32 v[154:155], v5 offset0:48 offset1:176
  ds_read_b32 v7, v7
  v_mfma_f32_16x16x32_bf16 v[96:99], v[176:179], v[184:187], v[96:99]
  v_lshlrev_b32 v1, 4, v0
  s_mul_i32 s3, s59, 6
  v_mfma_f32_16x16x32_bf16 v[100:103], v[176:179], v[188:191], v[100:103]
  s_add_u32 s3, s3, s64
  s_lshl_b32 s66, s58, 1
  v_mfma_f32_16x16x32_bf16 v[104:107], v[176:179], v[192:195], v[104:107]
  s_add_u32 s66, s66, s63
  s_mul_i32 s66, s66, 68
  v_mfma_f32_16x16x32_bf16 v[108:111], v[176:179], v[196:199], v[108:111]
  s_add_u32 s66, s66, s3
  s_lshl_b32 s66, s66, 12
  v_mfma_f32_16x16x32_bf16 v[28:31], v[200:203], v[164:167], v[28:31]
  v_mfma_f32_16x16x32_bf16 v[32:35], v[204:207], v[164:167], v[32:35]
  v_mfma_f32_16x16x32_bf16 v[56:59], v[200:203], v[168:171], v[56:59]
  v_mfma_f32_16x16x32_bf16 v[60:63], v[204:207], v[168:171], v[60:63]
  v_mfma_f32_16x16x32_bf16 v[84:87], v[200:203], v[172:175], v[84:87]
  v_mfma_f32_16x16x32_bf16 v[88:91], v[204:207], v[172:175], v[88:91]
  v_mfma_f32_16x16x32_bf16 v[112:115], v[200:203], v[176:179], v[112:115]
  v_mfma_f32_16x16x32_bf16 v[116:119], v[204:207], v[176:179], v[116:119]
  s_waitcnt vmcnt(0)
  v_lshlrev_b32 v156, 16, v216
  v_and_b32 v157, 0xffff0000, v216
  v_lshlrev_b32 v158, 16, v217
  v_and_b32 v159, 0xffff0000, v217
  v_lshlrev_b32 v160, 16, v218
  v_and_b32 v161, 0xffff0000, v218
  v_lshlrev_b32 v162, 16, v219
  v_and_b32 v163, 0xffff0000, v219
  v_mov_b32 v172, 0xbdd2d3e8
  v_mov_b32 v174, 0xc0135761
  v_mov_b32 v173, 0x3fb8aa3b
  v_mov_b32 v175, 0x358637bd
  s_waitcnt lgkmcnt(0)
  v_readfirstlane_b32 s54, v7
  v_and_b32 v5, 8, v0
  v_cmp_eq_u32 vcc, 0, v5
  v_mov_b32 v6, 0
  v_mov_b32 v7, 0x3f803f80
  v_cndmask_b32 v5, v6, v175, vcc
  v_mov_b32 v4, v5
  s_lshl_b32 s3, s61, 13
  s_add_u32 s3, s3, 122880
  v_add_u32 v2, s3, v1
.p2align 3
  v_pk_fma_f32 v[176:177], v[240:241], v[120:121], v[174:175] op_sel:[0,0,1] op_sel_hi:[1,0,1] neg_lo:[1,0,0] neg_hi:[1,0,0]
  v_pk_fma_f32 v[178:179], v[242:243], v[120:121], v[174:175] op_sel:[0,0,1] op_sel_hi:[1,0,1] neg_lo:[1,0,0] neg_hi:[1,0,0]
  v_pk_fma_f32 v[180:181], v[240:241], v[124:125], v[174:175] op_sel:[0,0,1] op_sel_hi:[1,0,1] neg_lo:[1,0,0] neg_hi:[1,0,0]
  v_pk_fma_f32 v[182:183], v[242:243], v[124:125], v[174:175] op_sel:[0,0,1] op_sel_hi:[1,0,1] neg_lo:[1,0,0] neg_hi:[1,0,0]
  v_pk_fma_f32 v[184:185], v[240:241], v[128:129], v[4:5] op_sel:[0,0,0] op_sel_hi:[1,0,1] neg_lo:[1,0,0] neg_hi:[1,0,0]
  v_pk_fma_f32 v[186:187], v[242:243], v[128:129], v[4:5] op_sel:[0,0,0] op_sel_hi:[1,0,1] neg_lo:[1,0,0] neg_hi:[1,0,0]
  v_pk_mul_f32 v[188:189], v[240:241], v[132:133] op_sel:[0,0] op_sel_hi:[1,0] neg_lo:[1,0] neg_hi:[1,0]
  v_pk_mul_f32 v[190:191], v[242:243], v[132:133] op_sel:[0,0] op_sel_hi:[1,0] neg_lo:[1,0] neg_hi:[1,0]
  v_pk_mul_f32 v[192:193], v[240:241], v[136:137] op_sel:[0,0] op_sel_hi:[1,0] neg_lo:[1,0] neg_hi:[1,0]
  v_pk_mul_f32 v[194:195], v[242:243], v[136:137] op_sel:[0,0] op_sel_hi:[1,0] neg_lo:[1,0] neg_hi:[1,0]
  v_pk_fma_f32 v[8:9], v[224:225], v[8:9], v[176:177]
  v_pk_fma_f32 v[10:11], v[226:227], v[10:11], v[178:179]
  v_pk_fma_f32 v[12:13], v[224:225], v[12:13], v[180:181]
  v_pk_fma_f32 v[14:15], v[226:227], v[14:15], v[182:183]
  v_pk_fma_f32 v[16:17], v[224:225], v[16:17], v[184:185]
  v_pk_fma_f32 v[18:19], v[226:227], v[18:19], v[186:187]
  v_pk_fma_f32 v[20:21], v[224:225], v[20:21], v[188:189]
  v_pk_fma_f32 v[22:23], v[226:227], v[22:23], v[190:191]
  v_pk_fma_f32 v[24:25], v[224:225], v[24:25], v[192:193]
  v_pk_fma_f32 v[26:27], v[226:227], v[26:27], v[194:195]
  v_cvt_pk_bf16_f32 v196, v16, v17
  v_cvt_pk_bf16_f32 v197, v18, v19
  v_pk_mul_f32 v[176:177], v[172:173], v[8:9] op_sel:[1,0] op_sel_hi:[1,1]
  v_pk_mul_f32 v[178:179], v[172:173], v[10:11] op_sel:[1,0] op_sel_hi:[1,1]
  v_pk_mul_f32 v[180:181], v[172:173], v[12:13] op_sel:[1,0] op_sel_hi:[1,1]
  v_pk_mul_f32 v[182:183], v[172:173], v[14:15] op_sel:[1,0] op_sel_hi:[1,1]
  v_pk_mul_f32 v[184:185], v[172:173], v[16:17] op_sel:[1,0] op_sel_hi:[1,1]
  v_pk_mul_f32 v[186:187], v[172:173], v[18:19] op_sel:[1,0] op_sel_hi:[1,1]
  v_exp_f32_e64 v176, v176 clamp
  v_exp_f32_e64 v177, v177 clamp
  v_exp_f32_e64 v178, v178 clamp
  v_exp_f32_e64 v179, v179 clamp
  v_exp_f32_e64 v180, v180 clamp
  v_exp_f32_e64 v181, v181 clamp
  v_exp_f32_e64 v182, v182 clamp
  v_exp_f32_e64 v183, v183 clamp
  v_exp_f32_e64 v184, v184 clamp
  v_exp_f32_e64 v185, v185 clamp
  v_exp_f32_e64 v186, v186 clamp
  v_exp_f32_e64 v187, v187 clamp
  v_max_f32 v8, v8, v175
  v_max_f32 v9, v9, v175
  v_max_f32 v10, v10, v175
  v_max_f32 v11, v11, v175
  v_max_f32 v12, v12, v175
  v_max_f32 v13, v13, v175
  v_max_f32 v14, v14, v175
  v_max_f32 v15, v15, v175
  v_max_f32 v16, v16, v175
  v_max_f32 v17, v17, v175
  v_max_f32 v18, v18, v175
  v_max_f32 v19, v19, v175
  v_pk_add_f32 v[8:9], v[8:9], v[176:177]
  v_pk_add_f32 v[10:11], v[10:11], v[178:179]
  v_pk_add_f32 v[12:13], v[12:13], v[180:181]
  v_pk_add_f32 v[14:15], v[14:15], v[182:183]
  v_pk_add_f32 v[16:17], v[16:17], v[184:185]
  v_pk_add_f32 v[18:19], v[18:19], v[186:187]
  v_cndmask_b32 v208, v196, v7, vcc
  v_cndmask_b32 v209, v197, v7, vcc
  v_cvt_pk_bf16_f32 v20, v20, v21
  v_cvt_pk_bf16_f32 v21, v22, v23
  v_cvt_pk_bf16_f32 v24, v24, v25
  v_cvt_pk_bf16_f32 v25, v26, v27
  v_cvt_pk_bf16_f32 v8, v8, v9
  v_cvt_pk_bf16_f32 v9, v10, v11
  v_cvt_pk_bf16_f32 v12, v12, v13
  v_cvt_pk_bf16_f32 v13, v14, v15
  v_cvt_pk_bf16_f32 v16, v16, v17
  v_cvt_pk_bf16_f32 v17, v18, v19
.p2align 3
  v_pk_fma_f32 v[176:177], v[244:245], v[120:121], v[174:175] op_sel:[0,0,1] op_sel_hi:[1,0,1] neg_lo:[1,0,0] neg_hi:[1,0,0]
  v_pk_fma_f32 v[178:179], v[246:247], v[120:121], v[174:175] op_sel:[0,0,1] op_sel_hi:[1,0,1] neg_lo:[1,0,0] neg_hi:[1,0,0]
  v_pk_fma_f32 v[180:181], v[244:245], v[124:125], v[174:175] op_sel:[0,0,1] op_sel_hi:[1,0,1] neg_lo:[1,0,0] neg_hi:[1,0,0]
  v_pk_fma_f32 v[182:183], v[246:247], v[124:125], v[174:175] op_sel:[0,0,1] op_sel_hi:[1,0,1] neg_lo:[1,0,0] neg_hi:[1,0,0]
  v_pk_fma_f32 v[184:185], v[244:245], v[128:129], v[4:5] op_sel:[0,0,0] op_sel_hi:[1,0,1] neg_lo:[1,0,0] neg_hi:[1,0,0]
  v_pk_fma_f32 v[186:187], v[246:247], v[128:129], v[4:5] op_sel:[0,0,0] op_sel_hi:[1,0,1] neg_lo:[1,0,0] neg_hi:[1,0,0]
  v_pk_mul_f32 v[188:189], v[244:245], v[132:133] op_sel:[0,0] op_sel_hi:[1,0] neg_lo:[1,0] neg_hi:[1,0]
  v_pk_mul_f32 v[190:191], v[246:247], v[132:133] op_sel:[0,0] op_sel_hi:[1,0] neg_lo:[1,0] neg_hi:[1,0]
  v_pk_mul_f32 v[192:193], v[244:245], v[136:137] op_sel:[0,0] op_sel_hi:[1,0] neg_lo:[1,0] neg_hi:[1,0]
  v_pk_mul_f32 v[194:195], v[246:247], v[136:137] op_sel:[0,0] op_sel_hi:[1,0] neg_lo:[1,0] neg_hi:[1,0]
  v_pk_fma_f32 v[36:37], v[228:229], v[36:37], v[176:177]
  v_pk_fma_f32 v[38:39], v[230:231], v[38:39], v[178:179]
  v_pk_fma_f32 v[40:41], v[228:229], v[40:41], v[180:181]
  v_pk_fma_f32 v[42:43], v[230:231], v[42:43], v[182:183]
  v_pk_fma_f32 v[44:45], v[228:229], v[44:45], v[184:185]
  v_pk_fma_f32 v[46:47], v[230:231], v[46:47], v[186:187]
  v_pk_fma_f32 v[48:49], v[228:229], v[48:49], v[188:189]
  v_pk_fma_f32 v[50:51], v[230:231], v[50:51], v[190:191]
  v_pk_fma_f32 v[52:53], v[228:229], v[52:53], v[192:193]
  v_pk_fma_f32 v[54:55], v[230:231], v[54:55], v[194:195]
  v_cvt_pk_bf16_f32 v196, v44, v45
  v_cvt_pk_bf16_f32 v197, v46, v47
  v_pk_mul_f32 v[176:177], v[172:173], v[36:37] op_sel:[1,0] op_sel_hi:[1,1]
  v_pk_mul_f32 v[178:179], v[172:173], v[38:39] op_sel:[1,0] op_sel_hi:[1,1]
  v_pk_mul_f32 v[180:181], v[172:173], v[40:41] op_sel:[1,0] op_sel_hi:[1,1]
  v_pk_mul_f32 v[182:183], v[172:173], v[42:43] op_sel:[1,0] op_sel_hi:[1,1]
  v_pk_mul_f32 v[184:185], v[172:173], v[44:45] op_sel:[1,0] op_sel_hi:[1,1]
  v_pk_mul_f32 v[186:187], v[172:173], v[46:47] op_sel:[1,0] op_sel_hi:[1,1]
  v_exp_f32_e64 v176, v176 clamp
  v_exp_f32_e64 v177, v177 clamp
  v_exp_f32_e64 v178, v178 clamp
  v_exp_f32_e64 v179, v179 clamp
  v_exp_f32_e64 v180, v180 clamp
  v_exp_f32_e64 v181, v181 clamp
  v_exp_f32_e64 v182, v182 clamp
  v_exp_f32_e64 v183, v183 clamp
  v_exp_f32_e64 v184, v184 clamp
  v_exp_f32_e64 v185, v185 clamp
  v_exp_f32_e64 v186, v186 clamp
  v_exp_f32_e64 v187, v187 clamp
  v_max_f32 v36, v36, v175
  v_max_f32 v37, v37, v175
  v_max_f32 v38, v38, v175
  v_max_f32 v39, v39, v175
  v_max_f32 v40, v40, v175
  v_max_f32 v41, v41, v175
  v_max_f32 v42, v42, v175
  v_max_f32 v43, v43, v175
  v_max_f32 v44, v44, v175
  v_max_f32 v45, v45, v175
  v_max_f32 v46, v46, v175
  v_max_f32 v47, v47, v175
  v_pk_add_f32 v[36:37], v[36:37], v[176:177]
  v_pk_add_f32 v[38:39], v[38:39], v[178:179]
  v_pk_add_f32 v[40:41], v[40:41], v[180:181]
  v_pk_add_f32 v[42:43], v[42:43], v[182:183]
  v_pk_add_f32 v[44:45], v[44:45], v[184:185]
  v_pk_add_f32 v[46:47], v[46:47], v[186:187]
  v_cndmask_b32 v210, v196, v7, vcc
  v_cndmask_b32 v211, v197, v7, vcc
  v_cvt_pk_bf16_f32 v22, v48, v49
  v_cvt_pk_bf16_f32 v23, v50, v51
  v_cvt_pk_bf16_f32 v26, v52, v53
  v_cvt_pk_bf16_f32 v27, v54, v55
  v_cvt_pk_bf16_f32 v10, v36, v37
  v_cvt_pk_bf16_f32 v11, v38, v39
  v_cvt_pk_bf16_f32 v14, v40, v41
  v_cvt_pk_bf16_f32 v15, v42, v43
  v_cvt_pk_bf16_f32 v18, v44, v45
  v_cvt_pk_bf16_f32 v19, v46, v47
.p2align 3
  v_pk_fma_f32 v[176:177], v[248:249], v[120:121], v[174:175] op_sel:[0,0,1] op_sel_hi:[1,0,1] neg_lo:[1,0,0] neg_hi:[1,0,0]
  v_pk_fma_f32 v[178:179], v[250:251], v[120:121], v[174:175] op_sel:[0,0,1] op_sel_hi:[1,0,1] neg_lo:[1,0,0] neg_hi:[1,0,0]
  v_pk_fma_f32 v[180:181], v[248:249], v[124:125], v[174:175] op_sel:[0,0,1] op_sel_hi:[1,0,1] neg_lo:[1,0,0] neg_hi:[1,0,0]
  v_pk_fma_f32 v[182:183], v[250:251], v[124:125], v[174:175] op_sel:[0,0,1] op_sel_hi:[1,0,1] neg_lo:[1,0,0] neg_hi:[1,0,0]
  v_pk_fma_f32 v[184:185], v[248:249], v[128:129], v[4:5] op_sel:[0,0,0] op_sel_hi:[1,0,1] neg_lo:[1,0,0] neg_hi:[1,0,0]
  v_pk_fma_f32 v[186:187], v[250:251], v[128:129], v[4:5] op_sel:[0,0,0] op_sel_hi:[1,0,1] neg_lo:[1,0,0] neg_hi:[1,0,0]
  v_pk_mul_f32 v[188:189], v[248:249], v[132:133] op_sel:[0,0] op_sel_hi:[1,0] neg_lo:[1,0] neg_hi:[1,0]
  v_pk_mul_f32 v[190:191], v[250:251], v[132:133] op_sel:[0,0] op_sel_hi:[1,0] neg_lo:[1,0] neg_hi:[1,0]
  v_pk_mul_f32 v[192:193], v[248:249], v[136:137] op_sel:[0,0] op_sel_hi:[1,0] neg_lo:[1,0] neg_hi:[1,0]
  v_pk_mul_f32 v[194:195], v[250:251], v[136:137] op_sel:[0,0] op_sel_hi:[1,0] neg_lo:[1,0] neg_hi:[1,0]
  v_pk_fma_f32 v[64:65], v[232:233], v[64:65], v[176:177]
  v_pk_fma_f32 v[66:67], v[234:235], v[66:67], v[178:179]
  v_pk_fma_f32 v[68:69], v[232:233], v[68:69], v[180:181]
  v_pk_fma_f32 v[70:71], v[234:235], v[70:71], v[182:183]
  v_pk_fma_f32 v[72:73], v[232:233], v[72:73], v[184:185]
  v_pk_fma_f32 v[74:75], v[234:235], v[74:75], v[186:187]
  v_pk_fma_f32 v[76:77], v[232:233], v[76:77], v[188:189]
  v_pk_fma_f32 v[78:79], v[234:235], v[78:79], v[190:191]
  v_pk_fma_f32 v[80:81], v[232:233], v[80:81], v[192:193]
  v_pk_fma_f32 v[82:83], v[234:235], v[82:83], v[194:195]
  v_cvt_pk_bf16_f32 v196, v72, v73
  v_cvt_pk_bf16_f32 v197, v74, v75
  v_pk_mul_f32 v[176:177], v[172:173], v[64:65] op_sel:[1,0] op_sel_hi:[1,1]
  v_pk_mul_f32 v[178:179], v[172:173], v[66:67] op_sel:[1,0] op_sel_hi:[1,1]
  v_pk_mul_f32 v[180:181], v[172:173], v[68:69] op_sel:[1,0] op_sel_hi:[1,1]
  v_pk_mul_f32 v[182:183], v[172:173], v[70:71] op_sel:[1,0] op_sel_hi:[1,1]
  v_pk_mul_f32 v[184:185], v[172:173], v[72:73] op_sel:[1,0] op_sel_hi:[1,1]
  v_pk_mul_f32 v[186:187], v[172:173], v[74:75] op_sel:[1,0] op_sel_hi:[1,1]
  v_exp_f32_e64 v176, v176 clamp
  v_exp_f32_e64 v177, v177 clamp
  v_mfma_f32_16x16x32_bf16 v[36:39], v[8:11], v[208:211], 0
  v_exp_f32_e64 v178, v178 clamp
  v_exp_f32_e64 v179, v179 clamp
  v_mfma_f32_16x16x32_bf16 v[40:43], v[8:11], v[20:23], 0
  v_exp_f32_e64 v180, v180 clamp
  v_exp_f32_e64 v181, v181 clamp
  v_mfma_f32_16x16x32_bf16 v[44:47], v[12:15], v[208:211], 0
  v_exp_f32_e64 v182, v182 clamp
  v_exp_f32_e64 v183, v183 clamp
  v_mfma_f32_16x16x32_bf16 v[48:51], v[12:15], v[20:23], 0
  v_exp_f32_e64 v184, v184 clamp
  v_exp_f32_e64 v185, v185 clamp
  v_mfma_f32_16x16x32_bf16 v[52:55], v[12:15], v[24:27], 0
  v_exp_f32_e64 v186, v186 clamp
  v_exp_f32_e64 v187, v187 clamp
  v_mfma_f32_16x16x32_bf16 v[216:219], v[16:19], v[208:211], 0
  v_max_f32 v64, v64, v175
  v_max_f32 v65, v65, v175
  v_mfma_f32_16x16x32_bf16 v[220:223], v[16:19], v[20:23], 0
  v_max_f32 v66, v66, v175
  v_max_f32 v67, v67, v175
  v_mfma_f32_16x16x32_bf16 v[224:227], v[16:19], v[24:27], 0
  v_max_f32 v68, v68, v175
  v_max_f32 v69, v69, v175
  v_max_f32 v70, v70, v175
  v_max_f32 v71, v71, v175
  v_max_f32 v72, v72, v175
  v_max_f32 v73, v73, v175
  v_max_f32 v74, v74, v175
  v_max_f32 v75, v75, v175
  v_pk_add_f32 v[64:65], v[64:65], v[176:177]
  v_pk_add_f32 v[66:67], v[66:67], v[178:179]
  v_pk_add_f32 v[68:69], v[68:69], v[180:181]
  v_pk_add_f32 v[70:71], v[70:71], v[182:183]
  v_pk_add_f32 v[72:73], v[72:73], v[184:185]
  v_pk_add_f32 v[74:75], v[74:75], v[186:187]
  v_cndmask_b32 v212, v196, v7, vcc
  v_cndmask_b32 v213, v197, v7, vcc
  v_cvt_pk_bf16_f32 v76, v76, v77
  v_cvt_pk_bf16_f32 v77, v78, v79
  v_cvt_pk_bf16_f32 v80, v80, v81
  v_cvt_pk_bf16_f32 v81, v82, v83
  v_cvt_pk_bf16_f32 v64, v64, v65
  v_cvt_pk_bf16_f32 v65, v66, v67
  v_cvt_pk_bf16_f32 v68, v68, v69
  v_cvt_pk_bf16_f32 v69, v70, v71
  v_cvt_pk_bf16_f32 v72, v72, v73
  v_cvt_pk_bf16_f32 v73, v74, v75
.p2align 3
  v_pk_fma_f32 v[176:177], v[252:253], v[120:121], v[174:175] op_sel:[0,0,1] op_sel_hi:[1,0,1] neg_lo:[1,0,0] neg_hi:[1,0,0]
  v_pk_fma_f32 v[178:179], v[254:255], v[120:121], v[174:175] op_sel:[0,0,1] op_sel_hi:[1,0,1] neg_lo:[1,0,0] neg_hi:[1,0,0]
  v_pk_fma_f32 v[180:181], v[252:253], v[124:125], v[174:175] op_sel:[0,0,1] op_sel_hi:[1,0,1] neg_lo:[1,0,0] neg_hi:[1,0,0]
  v_pk_fma_f32 v[182:183], v[254:255], v[124:125], v[174:175] op_sel:[0,0,1] op_sel_hi:[1,0,1] neg_lo:[1,0,0] neg_hi:[1,0,0]
  v_pk_fma_f32 v[184:185], v[252:253], v[128:129], v[4:5] op_sel:[0,0,0] op_sel_hi:[1,0,1] neg_lo:[1,0,0] neg_hi:[1,0,0]
  v_pk_fma_f32 v[186:187], v[254:255], v[128:129], v[4:5] op_sel:[0,0,0] op_sel_hi:[1,0,1] neg_lo:[1,0,0] neg_hi:[1,0,0]
  v_pk_mul_f32 v[188:189], v[252:253], v[132:133] op_sel:[0,0] op_sel_hi:[1,0] neg_lo:[1,0] neg_hi:[1,0]
  v_pk_mul_f32 v[190:191], v[254:255], v[132:133] op_sel:[0,0] op_sel_hi:[1,0] neg_lo:[1,0] neg_hi:[1,0]
  v_pk_mul_f32 v[192:193], v[252:253], v[136:137] op_sel:[0,0] op_sel_hi:[1,0] neg_lo:[1,0] neg_hi:[1,0]
  v_pk_mul_f32 v[194:195], v[254:255], v[136:137] op_sel:[0,0] op_sel_hi:[1,0] neg_lo:[1,0] neg_hi:[1,0]
  v_pk_fma_f32 v[92:93], v[236:237], v[92:93], v[176:177]
  v_pk_fma_f32 v[94:95], v[238:239], v[94:95], v[178:179]
  v_pk_fma_f32 v[96:97], v[236:237], v[96:97], v[180:181]
  v_pk_fma_f32 v[98:99], v[238:239], v[98:99], v[182:183]
  v_pk_fma_f32 v[100:101], v[236:237], v[100:101], v[184:185]
  v_pk_fma_f32 v[102:103], v[238:239], v[102:103], v[186:187]
  v_pk_fma_f32 v[104:105], v[236:237], v[104:105], v[188:189]
  v_pk_fma_f32 v[106:107], v[238:239], v[106:107], v[190:191]
  v_pk_fma_f32 v[108:109], v[236:237], v[108:109], v[192:193]
  v_pk_fma_f32 v[110:111], v[238:239], v[110:111], v[194:195]
  v_cvt_pk_bf16_f32 v196, v100, v101
  v_cvt_pk_bf16_f32 v197, v102, v103
  v_pk_mul_f32 v[176:177], v[172:173], v[92:93] op_sel:[1,0] op_sel_hi:[1,1]
  v_pk_mul_f32 v[178:179], v[172:173], v[94:95] op_sel:[1,0] op_sel_hi:[1,1]
  v_pk_mul_f32 v[180:181], v[172:173], v[96:97] op_sel:[1,0] op_sel_hi:[1,1]
  v_pk_mul_f32 v[182:183], v[172:173], v[98:99] op_sel:[1,0] op_sel_hi:[1,1]
  v_pk_mul_f32 v[184:185], v[172:173], v[100:101] op_sel:[1,0] op_sel_hi:[1,1]
  v_pk_mul_f32 v[186:187], v[172:173], v[102:103] op_sel:[1,0] op_sel_hi:[1,1]
  v_exp_f32_e64 v176, v176 clamp
  v_exp_f32_e64 v177, v177 clamp
  v_exp_f32_e64 v178, v178 clamp
  v_exp_f32_e64 v179, v179 clamp
  v_exp_f32_e64 v180, v180 clamp
  v_exp_f32_e64 v181, v181 clamp
  v_exp_f32_e64 v182, v182 clamp
  v_exp_f32_e64 v183, v183 clamp
  v_exp_f32_e64 v184, v184 clamp
  v_exp_f32_e64 v185, v185 clamp
  v_exp_f32_e64 v186, v186 clamp
  v_exp_f32_e64 v187, v187 clamp
  v_max_f32 v92, v92, v175
  v_max_f32 v93, v93, v175
  v_max_f32 v94, v94, v175
  v_max_f32 v95, v95, v175
  v_max_f32 v96, v96, v175
  v_max_f32 v97, v97, v175
  v_max_f32 v98, v98, v175
  v_max_f32 v99, v99, v175
  v_max_f32 v100, v100, v175
  v_max_f32 v101, v101, v175
  v_max_f32 v102, v102, v175
  v_max_f32 v103, v103, v175
  v_pk_add_f32 v[92:93], v[92:93], v[176:177]
  v_pk_add_f32 v[94:95], v[94:95], v[178:179]
  v_pk_add_f32 v[96:97], v[96:97], v[180:181]
  v_pk_add_f32 v[98:99], v[98:99], v[182:183]
  v_pk_add_f32 v[100:101], v[100:101], v[184:185]
  v_pk_add_f32 v[102:103], v[102:103], v[186:187]
  v_cndmask_b32 v214, v196, v7, vcc
  v_cndmask_b32 v215, v197, v7, vcc
  v_cvt_pk_bf16_f32 v78, v104, v105
  v_cvt_pk_bf16_f32 v79, v106, v107
  v_cvt_pk_bf16_f32 v82, v108, v109
  v_cvt_pk_bf16_f32 v83, v110, v111
  v_cvt_pk_bf16_f32 v66, v92, v93
  v_cvt_pk_bf16_f32 v67, v94, v95
  v_cvt_pk_bf16_f32 v70, v96, v97
  v_cvt_pk_bf16_f32 v71, v98, v99
  v_cvt_pk_bf16_f32 v74, v100, v101
  v_cvt_pk_bf16_f32 v75, v102, v103
  s_nop 1
  v_mfma_f32_16x16x32_bf16 v[36:39], v[64:67], v[212:215], v[36:39]
  v_mfma_f32_16x16x32_bf16 v[40:43], v[64:67], v[76:79], v[40:43]
  v_mfma_f32_16x16x32_bf16 v[44:47], v[68:71], v[212:215], v[44:47]
  v_mfma_f32_16x16x32_bf16 v[48:51], v[68:71], v[76:79], v[48:51]
  v_mfma_f32_16x16x32_bf16 v[52:55], v[68:71], v[80:83], v[52:55]
  v_mfma_f32_16x16x32_bf16 v[216:219], v[72:75], v[212:215], v[216:219]
  v_mfma_f32_16x16x32_bf16 v[220:223], v[72:75], v[76:79], v[220:223]
  v_mfma_f32_16x16x32_bf16 v[224:227], v[72:75], v[80:83], v[224:227]
  s_nop 0
  ds_write_b128 v2, v[36:39] offset:0
  ds_write_b128 v2, v[40:43] offset:1024
  ds_write_b128 v2, v[44:47] offset:2048
  ds_write_b128 v2, v[48:51] offset:3072
  ds_write_b128 v2, v[52:55] offset:4096
  ds_write_b128 v2, v[216:219] offset:5120
  ds_write_b128 v2, v[220:223] offset:6144
  ds_write_b128 v2, v[224:227] offset:7168
  v_mov_b32 v2, 160260
  v_mov_b32 v3, 1
  s_mov_b64 exec, 1
  s_waitcnt lgkmcnt(0)
  ds_add_u32 v2, v3
  s_mov_b64 exec, -1
  v_lshlrev_b32 v1, 4, v0
  v_add_u32 v2, 4096, v1
  s_mul_i32 s83, s61, 12
  s_mul_i32 s3, s81, 68
  s_add_u32 s36, s3, s83
  s_lshl_b32 s36, s36, 12
  s_mul_i32 s3, s82, 5120
  s_add_u32 s3, s3, 0x900000
  s_mul_i32 s39, s83, 40960
  s_add_u32 s39, s39, s3
  s_xor_b32 s56, s60, 0
  s_lshl_b32 s3, s56, 12
  s_add_u32 s44, s36, s3
  s_mul_i32 s3, s56, 40960
  s_add_u32 s45, s39, s3
.p2align 3
  v_pk_fma_f32 v[176:177], v[148:149], v[140:141], v[156:157] op_sel:[1,0,0] op_sel_hi:[1,1,1] neg_lo:[1,0,0] neg_hi:[1,0,0]
  v_pk_fma_f32 v[178:179], v[148:149], v[142:143], v[158:159] op_sel:[1,0,0] op_sel_hi:[1,1,1] neg_lo:[1,0,0] neg_hi:[1,0,0]
  v_pk_fma_f32 v[180:181], v[148:149], v[144:145], v[160:161] op_sel:[1,0,0] op_sel_hi:[1,1,1] neg_lo:[1,0,0] neg_hi:[1,0,0]
  v_pk_fma_f32 v[182:183], v[148:149], v[146:147], v[162:163] op_sel:[1,0,0] op_sel_hi:[1,1,1] neg_lo:[1,0,0] neg_hi:[1,0,0]
  v_pk_fma_f32 v[28:29], v[148:149], v[28:29], v[176:177] op_sel:[0,0,0] op_sel_hi:[0,1,1]
  v_pk_fma_f32 v[30:31], v[148:149], v[30:31], v[178:179] op_sel:[0,0,0] op_sel_hi:[0,1,1]
  v_pk_fma_f32 v[32:33], v[148:149], v[32:33], v[180:181] op_sel:[0,0,0] op_sel_hi:[0,1,1]
  v_pk_fma_f32 v[34:35], v[148:149], v[34:35], v[182:183] op_sel:[0,0,0] op_sel_hi:[0,1,1]
  v_pk_mul_f32 v[176:177], v[28:29], v[28:29]
  v_pk_mul_f32 v[178:179], v[30:31], v[30:31]
  v_pk_mul_f32 v[180:181], v[32:33], v[32:33]
  v_pk_mul_f32 v[182:183], v[34:35], v[34:35]
  v_pk_fma_f32 v[176:177], v[176:177], v[172:173], v[174:175] op_sel:[0,0,0] op_sel_hi:[1,0,0]
  v_pk_fma_f32 v[178:179], v[178:179], v[172:173], v[174:175] op_sel:[0,0,0] op_sel_hi:[1,0,0]
  v_pk_fma_f32 v[180:181], v[180:181], v[172:173], v[174:175] op_sel:[0,0,0] op_sel_hi:[1,0,0]
  v_pk_fma_f32 v[182:183], v[182:183], v[172:173], v[174:175] op_sel:[0,0,0] op_sel_hi:[1,0,0]
  v_pk_mul_f32 v[176:177], v[176:177], v[28:29]
  v_pk_mul_f32 v[178:179], v[178:179], v[30:31]
  v_pk_mul_f32 v[180:181], v[180:181], v[32:33]
  v_pk_mul_f32 v[182:183], v[182:183], v[34:35]
  v_exp_f32 v176, v176
  v_exp_f32 v177, v177
  v_exp_f32 v178, v178
  v_exp_f32 v179, v179
  v_exp_f32 v180, v180
  v_exp_f32 v181, v181
  v_exp_f32 v182, v182
  v_exp_f32 v183, v183
  v_pk_add_f32 v[176:177], v[176:177], 1.0 op_sel_hi:[1,0]
  v_pk_add_f32 v[178:179], v[178:179], 1.0 op_sel_hi:[1,0]
  v_pk_add_f32 v[180:181], v[180:181], 1.0 op_sel_hi:[1,0]
  v_pk_add_f32 v[182:183], v[182:183], 1.0 op_sel_hi:[1,0]
  v_rcp_f32 v176, v176
  v_rcp_f32 v177, v177
  v_rcp_f32 v178, v178
  v_rcp_f32 v179, v179
  v_rcp_f32 v180, v180
  v_rcp_f32 v181, v181
  v_rcp_f32 v182, v182
  v_rcp_f32 v183, v183
  v_pk_mul_f32 v[176:177], v[176:177], v[28:29]
  v_pk_mul_f32 v[178:179], v[178:179], v[30:31]
  v_pk_mul_f32 v[180:181], v[180:181], v[32:33]
  v_pk_mul_f32 v[182:183], v[182:183], v[34:35]
  v_cvt_pk_bf16_f32 v28, v176, v177
  v_cvt_pk_bf16_f32 v29, v178, v179
  v_cvt_pk_bf16_f32 v30, v180, v181
  v_cvt_pk_bf16_f32 v31, v182, v183
  s_cmp_lg_u32 s54, 0
  s_cbranch_scc0 Lsl_19
  buffer_store_dwordx4 v[28:31], v1, s[16:19], s66 offen offset:0
Lsl_19_b:
  s_add_u32 s3, s39, 245760
  buffer_load_dwordx4 v[20:23], v1, s[16:19], s3 offen offset:0 sc1
  buffer_load_dwordx4 v[24:27], v1, s[16:19], s3 offen offset:1024 sc1
  buffer_load_dwordx4 v[48:51], v1, s[16:19], s3 offen offset:2048 sc1
  buffer_load_dwordx4 v[52:55], v1, s[16:19], s3 offen offset:3072 sc1
  buffer_load_dwordx4 v[76:79], v2, s[16:19], s3 offen sc1
.p2align 3
  v_pk_fma_f32 v[176:177], v[150:151], v[140:141], v[156:157] op_sel:[1,0,0] op_sel_hi:[1,1,1] neg_lo:[1,0,0] neg_hi:[1,0,0]
  v_pk_fma_f32 v[178:179], v[150:151], v[142:143], v[158:159] op_sel:[1,0,0] op_sel_hi:[1,1,1] neg_lo:[1,0,0] neg_hi:[1,0,0]
  v_pk_fma_f32 v[180:181], v[150:151], v[144:145], v[160:161] op_sel:[1,0,0] op_sel_hi:[1,1,1] neg_lo:[1,0,0] neg_hi:[1,0,0]
  v_pk_fma_f32 v[182:183], v[150:151], v[146:147], v[162:163] op_sel:[1,0,0] op_sel_hi:[1,1,1] neg_lo:[1,0,0] neg_hi:[1,0,0]
  v_pk_fma_f32 v[56:57], v[150:151], v[56:57], v[176:177] op_sel:[0,0,0] op_sel_hi:[0,1,1]
  v_pk_fma_f32 v[58:59], v[150:151], v[58:59], v[178:179] op_sel:[0,0,0] op_sel_hi:[0,1,1]
  v_pk_fma_f32 v[60:61], v[150:151], v[60:61], v[180:181] op_sel:[0,0,0] op_sel_hi:[0,1,1]
  v_pk_fma_f32 v[62:63], v[150:151], v[62:63], v[182:183] op_sel:[0,0,0] op_sel_hi:[0,1,1]
  v_pk_mul_f32 v[176:177], v[56:57], v[56:57]
  v_pk_mul_f32 v[178:179], v[58:59], v[58:59]
  v_pk_mul_f32 v[180:181], v[60:61], v[60:61]
  v_pk_mul_f32 v[182:183], v[62:63], v[62:63]
  v_pk_fma_f32 v[176:177], v[176:177], v[172:173], v[174:175] op_sel:[0,0,0] op_sel_hi:[1,0,0]
  v_pk_fma_f32 v[178:179], v[178:179], v[172:173], v[174:175] op_sel:[0,0,0] op_sel_hi:[1,0,0]
  v_pk_fma_f32 v[180:181], v[180:181], v[172:173], v[174:175] op_sel:[0,0,0] op_sel_hi:[1,0,0]
  v_pk_fma_f32 v[182:183], v[182:183], v[172:173], v[174:175] op_sel:[0,0,0] op_sel_hi:[1,0,0]
  v_pk_mul_f32 v[176:177], v[176:177], v[56:57]
  v_pk_mul_f32 v[178:179], v[178:179], v[58:59]
  v_pk_mul_f32 v[180:181], v[180:181], v[60:61]
  v_pk_mul_f32 v[182:183], v[182:183], v[62:63]
  v_exp_f32 v176, v176
  v_exp_f32 v177, v177
  v_exp_f32 v178, v178
  v_exp_f32 v179, v179
  v_exp_f32 v180, v180
  v_exp_f32 v181, v181
  v_exp_f32 v182, v182
  v_exp_f32 v183, v183
  v_pk_add_f32 v[176:177], v[176:177], 1.0 op_sel_hi:[1,0]
  v_pk_add_f32 v[178:179], v[178:179], 1.0 op_sel_hi:[1,0]
  v_pk_add_f32 v[180:181], v[180:181], 1.0 op_sel_hi:[1,0]
  v_pk_add_f32 v[182:183], v[182:183], 1.0 op_sel_hi:[1,0]
  v_rcp_f32 v176, v176
  v_rcp_f32 v177, v177
  v_rcp_f32 v178, v178
  v_rcp_f32 v179, v179
  v_rcp_f32 v180, v180
  v_rcp_f32 v181, v181
  v_rcp_f32 v182, v182
  v_rcp_f32 v183, v183
  v_pk_mul_f32 v[176:177], v[176:177], v[56:57]
  v_pk_mul_f32 v[178:179], v[178:179], v[58:59]
  v_pk_mul_f32 v[180:181], v[180:181], v[60:61]
  v_pk_mul_f32 v[182:183], v[182:183], v[62:63]
  v_cvt_pk_bf16_f32 v56, v176, v177
  v_cvt_pk_bf16_f32 v57, v178, v179
  v_cvt_pk_bf16_f32 v58, v180, v181
  v_cvt_pk_bf16_f32 v59, v182, v183
  s_cmp_lg_u32 s54, 0
  s_cbranch_scc0 Lsl_20
  buffer_store_dwordx4 v[56:59], v1, s[16:19], s66 offen offset:1024
Lsl_20_b:
  s_add_u32 s3, s39, 286720
  buffer_load_dwordx4 v[80:83], v1, s[16:19], s3 offen offset:0 sc1
  buffer_load_dwordx4 v[104:107], v1, s[16:19], s3 offen offset:1024 sc1
  buffer_load_dwordx4 v[108:111], v1, s[16:19], s3 offen offset:2048 sc1
  buffer_load_dwordx4 v[216:219], v1, s[16:19], s3 offen offset:3072 sc1
  buffer_load_dwordx4 v[220:223], v2, s[16:19], s3 offen sc1
.p2align 3
  v_pk_fma_f32 v[176:177], v[152:153], v[140:141], v[156:157] op_sel:[1,0,0] op_sel_hi:[1,1,1] neg_lo:[1,0,0] neg_hi:[1,0,0]
  v_pk_fma_f32 v[178:179], v[152:153], v[142:143], v[158:159] op_sel:[1,0,0] op_sel_hi:[1,1,1] neg_lo:[1,0,0] neg_hi:[1,0,0]
  v_pk_fma_f32 v[180:181], v[152:153], v[144:145], v[160:161] op_sel:[1,0,0] op_sel_hi:[1,1,1] neg_lo:[1,0,0] neg_hi:[1,0,0]
  v_pk_fma_f32 v[182:183], v[152:153], v[146:147], v[162:163] op_sel:[1,0,0] op_sel_hi:[1,1,1] neg_lo:[1,0,0] neg_hi:[1,0,0]
  v_pk_fma_f32 v[84:85], v[152:153], v[84:85], v[176:177] op_sel:[0,0,0] op_sel_hi:[0,1,1]
  v_pk_fma_f32 v[86:87], v[152:153], v[86:87], v[178:179] op_sel:[0,0,0] op_sel_hi:[0,1,1]
  v_pk_fma_f32 v[88:89], v[152:153], v[88:89], v[180:181] op_sel:[0,0,0] op_sel_hi:[0,1,1]
  v_pk_fma_f32 v[90:91], v[152:153], v[90:91], v[182:183] op_sel:[0,0,0] op_sel_hi:[0,1,1]
  v_pk_mul_f32 v[176:177], v[84:85], v[84:85]
  v_pk_mul_f32 v[178:179], v[86:87], v[86:87]
  v_pk_mul_f32 v[180:181], v[88:89], v[88:89]
  v_pk_mul_f32 v[182:183], v[90:91], v[90:91]
  v_pk_fma_f32 v[176:177], v[176:177], v[172:173], v[174:175] op_sel:[0,0,0] op_sel_hi:[1,0,0]
  v_pk_fma_f32 v[178:179], v[178:179], v[172:173], v[174:175] op_sel:[0,0,0] op_sel_hi:[1,0,0]
  v_pk_fma_f32 v[180:181], v[180:181], v[172:173], v[174:175] op_sel:[0,0,0] op_sel_hi:[1,0,0]
  v_pk_fma_f32 v[182:183], v[182:183], v[172:173], v[174:175] op_sel:[0,0,0] op_sel_hi:[1,0,0]
  v_pk_mul_f32 v[176:177], v[176:177], v[84:85]
  v_pk_mul_f32 v[178:179], v[178:179], v[86:87]
  v_pk_mul_f32 v[180:181], v[180:181], v[88:89]
  v_pk_mul_f32 v[182:183], v[182:183], v[90:91]
  v_exp_f32 v176, v176
  v_exp_f32 v177, v177
  v_exp_f32 v178, v178
  v_exp_f32 v179, v179
  v_exp_f32 v180, v180
  v_exp_f32 v181, v181
  v_exp_f32 v182, v182
  v_exp_f32 v183, v183
  v_pk_add_f32 v[176:177], v[176:177], 1.0 op_sel_hi:[1,0]
  v_pk_add_f32 v[178:179], v[178:179], 1.0 op_sel_hi:[1,0]
  v_pk_add_f32 v[180:181], v[180:181], 1.0 op_sel_hi:[1,0]
  v_pk_add_f32 v[182:183], v[182:183], 1.0 op_sel_hi:[1,0]
  v_rcp_f32 v176, v176
  v_rcp_f32 v177, v177
  v_rcp_f32 v178, v178
  v_rcp_f32 v179, v179
  v_rcp_f32 v180, v180
  v_rcp_f32 v181, v181
  v_rcp_f32 v182, v182
  v_rcp_f32 v183, v183
  v_pk_mul_f32 v[176:177], v[176:177], v[84:85]
  v_pk_mul_f32 v[178:179], v[178:179], v[86:87]
  v_pk_mul_f32 v[180:181], v[180:181], v[88:89]
  v_pk_mul_f32 v[182:183], v[182:183], v[90:91]
  v_cvt_pk_bf16_f32 v84, v176, v177
  v_cvt_pk_bf16_f32 v85, v178, v179
  v_cvt_pk_bf16_f32 v86, v180, v181
  v_cvt_pk_bf16_f32 v87, v182, v183
  s_cmp_lg_u32 s54, 0
  s_cbranch_scc0 Lsl_21
  buffer_store_dwordx4 v[84:87], v1, s[16:19], s66 offen offset:2048
Lsl_21_b:
.p2align 3
  v_pk_fma_f32 v[176:177], v[154:155], v[140:141], v[156:157] op_sel:[1,0,0] op_sel_hi:[1,1,1] neg_lo:[1,0,0] neg_hi:[1,0,0]
  v_pk_fma_f32 v[178:179], v[154:155], v[142:143], v[158:159] op_sel:[1,0,0] op_sel_hi:[1,1,1] neg_lo:[1,0,0] neg_hi:[1,0,0]
  v_pk_fma_f32 v[180:181], v[154:155], v[144:145], v[160:161] op_sel:[1,0,0] op_sel_hi:[1,1,1] neg_lo:[1,0,0] neg_hi:[1,0,0]
  v_pk_fma_f32 v[182:183], v[154:155], v[146:147], v[162:163] op_sel:[1,0,0] op_sel_hi:[1,1,1] neg_lo:[1,0,0] neg_hi:[1,0,0]
  v_pk_fma_f32 v[112:113], v[154:155], v[112:113], v[176:177] op_sel:[0,0,0] op_sel_hi:[0,1,1]
  v_pk_fma_f32 v[114:115], v[154:155], v[114:115], v[178:179] op_sel:[0,0,0] op_sel_hi:[0,1,1]
  v_pk_fma_f32 v[116:117], v[154:155], v[116:117], v[180:181] op_sel:[0,0,0] op_sel_hi:[0,1,1]
  v_pk_fma_f32 v[118:119], v[154:155], v[118:119], v[182:183] op_sel:[0,0,0] op_sel_hi:[0,1,1]
  v_pk_mul_f32 v[176:177], v[112:113], v[112:113]
  v_pk_mul_f32 v[178:179], v[114:115], v[114:115]
  v_pk_mul_f32 v[180:181], v[116:117], v[116:117]
  v_pk_mul_f32 v[182:183], v[118:119], v[118:119]
  v_pk_fma_f32 v[176:177], v[176:177], v[172:173], v[174:175] op_sel:[0,0,0] op_sel_hi:[1,0,0]
  v_pk_fma_f32 v[178:179], v[178:179], v[172:173], v[174:175] op_sel:[0,0,0] op_sel_hi:[1,0,0]
  v_pk_fma_f32 v[180:181], v[180:181], v[172:173], v[174:175] op_sel:[0,0,0] op_sel_hi:[1,0,0]
  v_pk_fma_f32 v[182:183], v[182:183], v[172:173], v[174:175] op_sel:[0,0,0] op_sel_hi:[1,0,0]
  v_pk_mul_f32 v[176:177], v[176:177], v[112:113]
  v_pk_mul_f32 v[178:179], v[178:179], v[114:115]
  v_pk_mul_f32 v[180:181], v[180:181], v[116:117]
  v_pk_mul_f32 v[182:183], v[182:183], v[118:119]
  v_exp_f32 v176, v176
  v_exp_f32 v177, v177
  v_exp_f32 v178, v178
  v_exp_f32 v179, v179
  v_exp_f32 v180, v180
  v_exp_f32 v181, v181
  v_exp_f32 v182, v182
  v_exp_f32 v183, v183
  v_pk_add_f32 v[176:177], v[176:177], 1.0 op_sel_hi:[1,0]
  v_pk_add_f32 v[178:179], v[178:179], 1.0 op_sel_hi:[1,0]
  v_pk_add_f32 v[180:181], v[180:181], 1.0 op_sel_hi:[1,0]
  v_pk_add_f32 v[182:183], v[182:183], 1.0 op_sel_hi:[1,0]
  v_rcp_f32 v176, v176
  v_rcp_f32 v177, v177
  v_rcp_f32 v178, v178
  v_rcp_f32 v179, v179
  v_rcp_f32 v180, v180
  v_rcp_f32 v181, v181
  v_rcp_f32 v182, v182
  v_rcp_f32 v183, v183
  v_pk_mul_f32 v[176:177], v[176:177], v[112:113]
  v_pk_mul_f32 v[178:179], v[178:179], v[114:115]
  v_pk_mul_f32 v[180:181], v[180:181], v[116:117]
  v_pk_mul_f32 v[182:183], v[182:183], v[118:119]
  v_cvt_pk_bf16_f32 v112, v176, v177
  v_cvt_pk_bf16_f32 v113, v178, v179
  v_cvt_pk_bf16_f32 v114, v180, v181
  v_cvt_pk_bf16_f32 v115, v182, v183
  s_cmp_lg_u32 s54, 0
  s_cbranch_scc0 Lsl_22
  buffer_store_dwordx4 v[112:115], v1, s[16:19], s66 offen offset:3072
Lsl_22_b:
  s_lshl_b32 s3, s58, 1
  s_add_u32 s3, s3, s63
  s_mul_i32 s3, s3, 240
  s_lshr_b32 s80, s66, 10
  s_add_u32 s3, s3, s80
  s_add_u32 s3, s3, 0xd14000
  v_mov_b32 v6, s62
  v_mov_b32 v7, 0
  s_mov_b64 exec, 1
  s_waitcnt vmcnt(0)
  s_cmp_lg_u32 s54, 0
  s_cbranch_scc0 Lsl_23
  buffer_store_dword v6, v7, s[16:19], s3 offen
Lsl_23_b:
  s_mov_b64 exec, -1
  s_nop 0
  s_branch L_g2early
L_cqh:
  s_mov_b32 s77, 0
  s_mov_b32 s76, 0
  s_waitcnt lgkmcnt(0)
  s_barrier
  ds_read_b128 v[120:123], v208 offset:0
  ds_read_b128 v[124:127], v208 offset:2048
  ds_read_b128 v[128:131], v208 offset:4096
  ds_read_b128 v[132:135], v208 offset:6144
  ds_read_b64_tr_b16 v[136:137], v210 offset:16384
  ds_read_b64_tr_b16 v[138:139], v210 offset:18944
  ds_read_b64_tr_b16 v[140:141], v210 offset:16416
  ds_read_b64_tr_b16 v[142:143], v210 offset:18976
  ds_read_b64_tr_b16 v[144:145], v211 offset:0
  ds_read_b64_tr_b16 v[146:147], v211 offset:2560
  ds_read_b64_tr_b16 v[148:149], v212 offset:0
  ds_read_b64_tr_b16 v[150:151], v212 offset:2048
  ds_read_b64_tr_b16 v[152:153], v213 offset:0
  ds_read_b64_tr_b16 v[154:155], v213 offset:2048
  ds_read_b64_tr_b16 v[156:157], v214 offset:0
  ds_read_b64_tr_b16 v[158:159], v214 offset:2048
  ds_read_b64_tr_b16 v[160:161], v215 offset:0
  ds_read_b64_tr_b16 v[162:163], v215 offset:2048
  s_cmp_eq_u32 s73, 0
  s_cbranch_scc1 L_ent1
  s_cmp_lg_u32 s63, 0
  s_cbranch_scc1 L_cs11
  ds_read_b64_tr_b16 v[180:181], v210 offset:21504
  ds_read_b64_tr_b16 v[182:183], v210 offset:24064
  ds_read_b64_tr_b16 v[184:185], v210 offset:21536
  ds_read_b64_tr_b16 v[186:187], v210 offset:24096
  ds_read_b64_tr_b16 v[188:189], v211 offset:5120
  ds_read_b64_tr_b16 v[190:191], v211 offset:7680
  ds_read_b64_tr_b16 v[192:193], v212 offset:4096
  ds_read_b64_tr_b16 v[194:195], v212 offset:6144
  s_waitcnt lgkmcnt(8)
  v_mfma_f32_16x16x32_bf16 v[252:255], v[136:139], v[236:239], 0
  v_mfma_f32_16x16x32_bf16 v[252:255], v[140:143], v[240:243], v[252:255]
  v_mfma_f32_16x16x32_bf16 v[252:255], v[144:147], v[244:247], v[252:255]
  v_mfma_f32_16x16x32_bf16 v[252:255], v[148:151], v[248:251], v[252:255]
  s_waitcnt lgkmcnt(0)
  v_mfma_f32_16x16x32_bf16 v[252:255], v[180:183], v[236:239], v[252:255]
  v_mfma_f32_16x16x32_bf16 v[252:255], v[184:187], v[240:243], v[252:255]
  v_mfma_f32_16x16x32_bf16 v[252:255], v[188:191], v[244:247], v[252:255]
  v_mfma_f32_16x16x32_bf16 v[252:255], v[192:195], v[248:251], v[252:255]
  s_mov_b32 s3, 0xf000f
  s_branch L_cs21
L_cs11:
  ds_read_b64_tr_b16 v[196:197], v213 offset:4096
  ds_read_b64_tr_b16 v[198:199], v213 offset:6144
  ds_read_b64_tr_b16 v[200:201], v214 offset:4096
  ds_read_b64_tr_b16 v[202:203], v214 offset:6144
  ds_read_b64_tr_b16 v[204:205], v215 offset:4096
  ds_read_b64_tr_b16 v[206:207], v215 offset:6144
  s_waitcnt lgkmcnt(6)
  v_mfma_f32_16x16x32_bf16 v[252:255], v[152:155], v[236:239], 0
  v_mfma_f32_16x16x32_bf16 v[252:255], v[156:159], v[240:243], v[252:255]
  v_mfma_f32_16x16x32_bf16 v[252:255], v[160:163], v[244:247], v[252:255]
  s_waitcnt lgkmcnt(0)
  v_mfma_f32_16x16x32_bf16 v[252:255], v[196:199], v[236:239], v[252:255]
  v_mfma_f32_16x16x32_bf16 v[252:255], v[200:203], v[240:243], v[252:255]
  v_mfma_f32_16x16x32_bf16 v[252:255], v[204:207], v[244:247], v[252:255]
  s_mov_b32 s3, 0x70007
L_cs21:
  s_nop 6
  v_bfi_b32 v252, v5, s40, v252
  v_bfi_b32 v253, v5, s41, v253
  v_bfi_b32 v254, v5, s48, v254
  v_bfi_b32 v255, v5, s49, v255
  s_mov_b32 exec_lo, s3
  s_mov_b32 exec_hi, s3
  buffer_store_dwordx4 v[252:255], v4, s[16:19], s73 offen sc1
  s_mov_b64 exec, -1
L_ent1:
  s_waitcnt lgkmcnt(0)
  s_branch L_mid1
.p2align 3
L_top1:
  s_barrier
  s_nop 0
  v_mfma_f32_16x16x32_bf16 v[8:11], v[180:183], v[164:167], v[8:11]
  ds_read_b128 v[120:123], v208 offset:0
  v_mfma_f32_16x16x32_bf16 v[36:39], v[180:183], v[168:171], v[36:39]
  ds_read_b128 v[124:127], v208 offset:2048
  v_mfma_f32_16x16x32_bf16 v[64:67], v[180:183], v[172:175], v[64:67]
  ds_read_b128 v[128:131], v208 offset:4096
  v_mfma_f32_16x16x32_bf16 v[92:95], v[180:183], v[176:179], v[92:95]
  ds_read_b128 v[132:135], v208 offset:6144
  v_mfma_f32_16x16x32_bf16 v[12:15], v[184:187], v[164:167], v[12:15]
  ds_read_b64_tr_b16 v[136:137], v210 offset:16384
  v_mfma_f32_16x16x32_bf16 v[40:43], v[184:187], v[168:171], v[40:43]
  ds_read_b64_tr_b16 v[138:139], v210 offset:18944
  v_mfma_f32_16x16x32_bf16 v[68:71], v[184:187], v[172:175], v[68:71]
  ds_read_b64_tr_b16 v[140:141], v210 offset:16416
  v_mfma_f32_16x16x32_bf16 v[96:99], v[184:187], v[176:179], v[96:99]
  ds_read_b64_tr_b16 v[142:143], v210 offset:18976
  v_mfma_f32_16x16x32_bf16 v[16:19], v[188:191], v[164:167], v[16:19]
  ds_read_b64_tr_b16 v[144:145], v211 offset:0
  v_mfma_f32_16x16x32_bf16 v[44:47], v[188:191], v[168:171], v[44:47]
  ds_read_b64_tr_b16 v[146:147], v211 offset:2560
  v_mfma_f32_16x16x32_bf16 v[72:75], v[188:191], v[172:175], v[72:75]
  ds_read_b64_tr_b16 v[148:149], v212 offset:0
  v_mfma_f32_16x16x32_bf16 v[100:103], v[188:191], v[176:179], v[100:103]
  ds_read_b64_tr_b16 v[150:151], v212 offset:2048
  v_mfma_f32_16x16x32_bf16 v[20:23], v[192:195], v[164:167], v[20:23]
  ds_read_b64_tr_b16 v[152:153], v213 offset:0
  v_mfma_f32_16x16x32_bf16 v[48:51], v[192:195], v[168:171], v[48:51]
  ds_read_b64_tr_b16 v[154:155], v213 offset:2048
  v_mfma_f32_16x16x32_bf16 v[76:79], v[192:195], v[172:175], v[76:79]
  ds_read_b64_tr_b16 v[156:157], v214 offset:0
  v_mfma_f32_16x16x32_bf16 v[104:107], v[192:195], v[176:179], v[104:107]
  ds_read_b64_tr_b16 v[158:159], v214 offset:2048
  v_mfma_f32_16x16x32_bf16 v[24:27], v[196:199], v[164:167], v[24:27]
  ds_read_b64_tr_b16 v[160:161], v215 offset:0
  v_mfma_f32_16x16x32_bf16 v[52:55], v[196:199], v[168:171], v[52:55]
  ds_read_b64_tr_b16 v[162:163], v215 offset:2048
  v_mfma_f32_16x16x32_bf16 v[80:83], v[196:199], v[172:175], v[80:83]
  v_mfma_f32_16x16x32_bf16 v[108:111], v[196:199], v[176:179], v[108:111]
  v_mfma_f32_16x16x32_bf16 v[28:31], v[200:203], v[164:167], v[28:31]
  v_mfma_f32_16x16x32_bf16 v[56:59], v[200:203], v[168:171], v[56:59]
  v_mfma_f32_16x16x32_bf16 v[84:87], v[200:203], v[172:175], v[84:87]
  v_mfma_f32_16x16x32_bf16 v[112:115], v[200:203], v[176:179], v[112:115]
  v_mfma_f32_16x16x32_bf16 v[32:35], v[204:207], v[164:167], v[32:35]
  v_mfma_f32_16x16x32_bf16 v[60:63], v[204:207], v[168:171], v[60:63]
  v_mfma_f32_16x16x32_bf16 v[88:91], v[204:207], v[172:175], v[88:91]
  v_mfma_f32_16x16x32_bf16 v[116:119], v[204:207], v[176:179], v[116:119]
  s_waitcnt lgkmcnt(0)
  s_nop 0
L_mid1:
  v_mfma_f32_16x16x32_bf16 v[8:11], v[136:139], v[120:123], v[8:11]
  ds_read_b128 v[164:167], v209 offset:0
  v_mfma_f32_16x16x32_bf16 v[36:39], v[136:139], v[124:127], v[36:39]
  ds_read_b128 v[168:171], v209 offset:2048
  v_mfma_f32_16x16x32_bf16 v[64:67], v[136:139], v[128:131], v[64:67]
  ds_read_b128 v[172:175], v209 offset:4096
  v_mfma_f32_16x16x32_bf16 v[92:95], v[136:139], v[132:135], v[92:95]
  ds_read_b128 v[176:179], v209 offset:6144
  v_mfma_f32_16x16x32_bf16 v[12:15], v[140:143], v[120:123], v[12:15]
  ds_read_b64_tr_b16 v[180:181], v210 offset:21504
  v_mfma_f32_16x16x32_bf16 v[40:43], v[140:143], v[124:127], v[40:43]
  ds_read_b64_tr_b16 v[182:183], v210 offset:24064
  v_mfma_f32_16x16x32_bf16 v[68:71], v[140:143], v[128:131], v[68:71]
  ds_read_b64_tr_b16 v[184:185], v210 offset:21536
  v_mfma_f32_16x16x32_bf16 v[96:99], v[140:143], v[132:135], v[96:99]
  ds_read_b64_tr_b16 v[186:187], v210 offset:24096
  v_mfma_f32_16x16x32_bf16 v[16:19], v[144:147], v[120:123], v[16:19]
  ds_read_b64_tr_b16 v[188:189], v211 offset:5120
  v_mfma_f32_16x16x32_bf16 v[44:47], v[144:147], v[124:127], v[44:47]
  ds_read_b64_tr_b16 v[190:191], v211 offset:7680
  v_mfma_f32_16x16x32_bf16 v[72:75], v[144:147], v[128:131], v[72:75]
  ds_read_b64_tr_b16 v[192:193], v212 offset:4096
  v_mfma_f32_16x16x32_bf16 v[100:103], v[144:147], v[132:135], v[100:103]
  ds_read_b64_tr_b16 v[194:195], v212 offset:6144
  v_mfma_f32_16x16x32_bf16 v[20:23], v[148:151], v[120:123], v[20:23]
  ds_read_b64_tr_b16 v[196:197], v213 offset:4096
  v_mfma_f32_16x16x32_bf16 v[48:51], v[148:151], v[124:127], v[48:51]
  ds_read_b64_tr_b16 v[198:199], v213 offset:6144
  v_mfma_f32_16x16x32_bf16 v[76:79], v[148:151], v[128:131], v[76:79]
  ds_read_b64_tr_b16 v[200:201], v214 offset:4096
  v_mfma_f32_16x16x32_bf16 v[104:107], v[148:151], v[132:135], v[104:107]
  ds_read_b64_tr_b16 v[202:203], v214 offset:6144
  v_mfma_f32_16x16x32_bf16 v[24:27], v[152:155], v[120:123], v[24:27]
  ds_read_b64_tr_b16 v[204:205], v215 offset:4096
  v_mfma_f32_16x16x32_bf16 v[52:55], v[152:155], v[124:127], v[52:55]
  ds_read_b64_tr_b16 v[206:207], v215 offset:6144
  v_mfma_f32_16x16x32_bf16 v[80:83], v[152:155], v[128:131], v[80:83]
  s_add_u32 s76, s76, 1
  s_cmp_eq_u32 s76, 3
  s_cselect_b32 s76, 0, s76
  s_mov_b32 s65, 45184
  s_cselect_b32 s65, 4294876928, s65
  s_add_u32 s77, s77, 1
  v_mfma_f32_16x16x32_bf16 v[108:111], v[152:155], v[132:135], v[108:111]
  v_add_u32_e64 v208, s65, v208
  v_mfma_f32_16x16x32_bf16 v[28:31], v[156:159], v[120:123], v[28:31]
  v_add_u32_e64 v209, s65, v209
  v_mfma_f32_16x16x32_bf16 v[56:59], v[156:159], v[124:127], v[56:59]
  v_add_u32_e64 v210, s65, v210
  v_mfma_f32_16x16x32_bf16 v[84:87], v[156:159], v[128:131], v[84:87]
  v_add_u32_e64 v211, s65, v211
  v_mfma_f32_16x16x32_bf16 v[112:115], v[156:159], v[132:135], v[112:115]
  v_add_u32_e64 v212, s65, v212
  v_mfma_f32_16x16x32_bf16 v[32:35], v[160:163], v[120:123], v[32:35]
  v_add_u32_e64 v213, s65, v213
  v_mfma_f32_16x16x32_bf16 v[60:63], v[160:163], v[124:127], v[60:63]
  v_add_u32_e64 v214, s65, v214
  v_mfma_f32_16x16x32_bf16 v[88:91], v[160:163], v[128:131], v[88:91]
  v_add_u32_e64 v215, s65, v215
  v_mfma_f32_16x16x32_bf16 v[116:119], v[160:163], v[132:135], v[116:119]
  s_cmp_lt_u32 s77, 10
  s_waitcnt lgkmcnt(0)
  s_cbranch_scc1 L_top1
  s_barrier
  v_mfma_f32_16x16x32_bf16 v[20:23], v[192:195], v[164:167], v[20:23]
  v_and_b32 v4, 15, v0
  v_lshlrev_b32 v4, 2, v4
  v_mfma_f32_16x16x32_bf16 v[24:27], v[196:199], v[164:167], v[24:27]
  s_lshl_b32 s3, s63, 8
  s_add_u32 s3, s3, 160768
  v_mfma_f32_16x16x32_bf16 v[48:51], v[192:195], v[168:171], v[48:51]
  v_add_u32 v5, s3, v4
  v_and_b32 v6, 48, v0
  v_mfma_f32_16x16x32_bf16 v[52:55], v[196:199], v[168:171], v[52:55]
  v_add_u32 v3, s3, v6
  s_mul_i32 s3, s64, 448
  v_mfma_f32_16x16x32_bf16 v[76:79], v[192:195], v[172:175], v[76:79]
  s_add_u32 s3, s3, 161792
  v_add_u32 v6, s3, v6
  v_mfma_f32_16x16x32_bf16 v[80:83], v[196:199], v[172:175], v[80:83]
  v_add_u32 v4, s3, v4
  v_mov_b32 v7, 160384
  v_mfma_f32_16x16x32_bf16 v[104:107], v[192:195], v[176:179], v[104:107]
  ds_read_b128 v[120:123], v6 offset:0
  ds_read_b128 v[124:127], v6 offset:64
  v_mfma_f32_16x16x32_bf16 v[108:111], v[196:199], v[176:179], v[108:111]
  ds_read_b128 v[128:131], v6 offset:128
  ds_read_b128 v[132:135], v6 offset:192
  v_mfma_f32_16x16x32_bf16 v[28:31], v[200:203], v[164:167], v[28:31]
  ds_read_b128 v[136:139], v6 offset:256
  ds_read_b128 v[140:143], v6 offset:320
  v_mfma_f32_16x16x32_bf16 v[32:35], v[204:207], v[164:167], v[32:35]
  ds_read_b128 v[144:147], v6 offset:384
  ds_read2_b32 v[148:149], v5 offset0:0 offset1:128
  v_mfma_f32_16x16x32_bf16 v[56:59], v[200:203], v[168:171], v[56:59]
  ds_read2_b32 v[150:151], v5 offset0:16 offset1:144
  ds_read2_b32 v[152:153], v5 offset0:32 offset1:160
  v_mfma_f32_16x16x32_bf16 v[60:63], v[204:207], v[168:171], v[60:63]
  ds_read2_b32 v[154:155], v5 offset0:48 offset1:176
  ds_read_b32 v7, v7
  v_mfma_f32_16x16x32_bf16 v[84:87], v[200:203], v[172:175], v[84:87]
  v_lshlrev_b32 v1, 4, v0
  s_mul_i32 s3, s59, 6
  v_mfma_f32_16x16x32_bf16 v[88:91], v[204:207], v[172:175], v[88:91]
  s_lshl_b32 s65, s64, 1
  s_add_u32 s3, s3, s65
  v_mfma_f32_16x16x32_bf16 v[112:115], v[200:203], v[176:179], v[112:115]
  s_add_u32 s3, s3, 2
  s_lshl_b32 s66, s58, 1
  v_mfma_f32_16x16x32_bf16 v[116:119], v[204:207], v[176:179], v[116:119]
  s_add_u32 s66, s66, s63
  s_mul_i32 s66, s66, 68
  v_mfma_f32_16x16x32_bf16 v[8:11], v[180:183], v[164:167], v[8:11]
  s_add_u32 s66, s66, s3
  s_lshl_b32 s66, s66, 12
  v_mfma_f32_16x16x32_bf16 v[12:15], v[184:187], v[164:167], v[12:15]
  s_add_u32 s67, s66, 4096
  v_mfma_f32_16x16x32_bf16 v[16:19], v[188:191], v[164:167], v[16:19]
  v_mfma_f32_16x16x32_bf16 v[36:39], v[180:183], v[168:171], v[36:39]
  v_mfma_f32_16x16x32_bf16 v[40:43], v[184:187], v[168:171], v[40:43]
  v_mfma_f32_16x16x32_bf16 v[44:47], v[188:191], v[168:171], v[44:47]
  v_mfma_f32_16x16x32_bf16 v[64:67], v[180:183], v[172:175], v[64:67]
  v_mfma_f32_16x16x32_bf16 v[68:71], v[184:187], v[172:175], v[68:71]
  v_mfma_f32_16x16x32_bf16 v[72:75], v[188:191], v[172:175], v[72:75]
  v_mfma_f32_16x16x32_bf16 v[92:95], v[180:183], v[176:179], v[92:95]
  v_mfma_f32_16x16x32_bf16 v[96:99], v[184:187], v[176:179], v[96:99]
  v_mfma_f32_16x16x32_bf16 v[100:103], v[188:191], v[176:179], v[100:103]
  s_waitcnt vmcnt(0)
  v_lshlrev_b32 v156, 16, v216
  v_and_b32 v157, 0xffff0000, v216
  v_lshlrev_b32 v158, 16, v217
  v_and_b32 v159, 0xffff0000, v217
  v_lshlrev_b32 v160, 16, v218
  v_and_b32 v161, 0xffff0000, v218
  v_lshlrev_b32 v162, 16, v219
  v_and_b32 v163, 0xffff0000, v219
  v_lshlrev_b32 v164, 16, v220
  v_and_b32 v165, 0xffff0000, v220
  v_lshlrev_b32 v166, 16, v221
  v_and_b32 v167, 0xffff0000, v221
  v_lshlrev_b32 v168, 16, v222
  v_and_b32 v169, 0xffff0000, v222
  v_lshlrev_b32 v170, 16, v223
  v_and_b32 v171, 0xffff0000, v223
  v_mov_b32 v172, 0xbdd2d3e8
  v_mov_b32 v174, 0xc0135761
  v_mov_b32 v173, 0x3fb8aa3b
  v_mov_b32 v175, 0x358637bd
  s_waitcnt lgkmcnt(0)
  v_readfirstlane_b32 s54, v7
  v_lshlrev_b32 v1, 4, v0
  v_add_u32 v2, 4096, v1
  s_mul_i32 s83, s61, 12
  s_mul_i32 s3, s81, 68
  s_add_u32 s36, s3, s83
  s_lshl_b32 s36, s36, 12
  s_mul_i32 s3, s82, 5120
  s_add_u32 s3, s3, 0x900000
  s_mul_i32 s39, s83, 40960
  s_add_u32 s39, s39, s3
  s_xor_b32 s56, s60, 0
  s_lshl_b32 s3, s56, 12
  s_add_u32 s44, s36, s3
  s_mul_i32 s3, s56, 40960
  s_add_u32 s45, s39, s3
.p2align 3
  v_pk_fma_f32 v[176:177], v[148:149], v[132:133], v[156:157] op_sel:[1,0,0] op_sel_hi:[1,1,1] neg_lo:[1,0,0] neg_hi:[1,0,0]
  v_pk_fma_f32 v[178:179], v[148:149], v[134:135], v[158:159] op_sel:[1,0,0] op_sel_hi:[1,1,1] neg_lo:[1,0,0] neg_hi:[1,0,0]
  v_pk_fma_f32 v[180:181], v[148:149], v[136:137], v[160:161] op_sel:[1,0,0] op_sel_hi:[1,1,1] neg_lo:[1,0,0] neg_hi:[1,0,0]
  v_pk_fma_f32 v[182:183], v[148:149], v[138:139], v[162:163] op_sel:[1,0,0] op_sel_hi:[1,1,1] neg_lo:[1,0,0] neg_hi:[1,0,0]
  v_pk_fma_f32 v[20:21], v[148:149], v[20:21], v[176:177] op_sel:[0,0,0] op_sel_hi:[0,1,1]
  v_pk_fma_f32 v[22:23], v[148:149], v[22:23], v[178:179] op_sel:[0,0,0] op_sel_hi:[0,1,1]
  v_pk_fma_f32 v[24:25], v[148:149], v[24:25], v[180:181] op_sel:[0,0,0] op_sel_hi:[0,1,1]
  v_pk_fma_f32 v[26:27], v[148:149], v[26:27], v[182:183] op_sel:[0,0,0] op_sel_hi:[0,1,1]
  v_pk_mul_f32 v[176:177], v[20:21], v[20:21]
  v_pk_mul_f32 v[178:179], v[22:23], v[22:23]
  v_pk_mul_f32 v[180:181], v[24:25], v[24:25]
  v_pk_mul_f32 v[182:183], v[26:27], v[26:27]
  v_pk_fma_f32 v[176:177], v[176:177], v[172:173], v[174:175] op_sel:[0,0,0] op_sel_hi:[1,0,0]
  v_pk_fma_f32 v[178:179], v[178:179], v[172:173], v[174:175] op_sel:[0,0,0] op_sel_hi:[1,0,0]
  v_pk_fma_f32 v[180:181], v[180:181], v[172:173], v[174:175] op_sel:[0,0,0] op_sel_hi:[1,0,0]
  v_pk_fma_f32 v[182:183], v[182:183], v[172:173], v[174:175] op_sel:[0,0,0] op_sel_hi:[1,0,0]
  v_pk_mul_f32 v[176:177], v[176:177], v[20:21]
  v_pk_mul_f32 v[178:179], v[178:179], v[22:23]
  v_pk_mul_f32 v[180:181], v[180:181], v[24:25]
  v_pk_mul_f32 v[182:183], v[182:183], v[26:27]
  v_exp_f32 v176, v176
  v_exp_f32 v177, v177
  v_exp_f32 v178, v178
  v_exp_f32 v179, v179
  v_exp_f32 v180, v180
  v_exp_f32 v181, v181
  v_exp_f32 v182, v182
  v_exp_f32 v183, v183
  v_pk_add_f32 v[176:177], v[176:177], 1.0 op_sel_hi:[1,0]
  v_pk_add_f32 v[178:179], v[178:179], 1.0 op_sel_hi:[1,0]
  v_pk_add_f32 v[180:181], v[180:181], 1.0 op_sel_hi:[1,0]
  v_pk_add_f32 v[182:183], v[182:183], 1.0 op_sel_hi:[1,0]
  v_rcp_f32 v176, v176
  v_rcp_f32 v177, v177
  v_rcp_f32 v178, v178
  v_rcp_f32 v179, v179
  v_rcp_f32 v180, v180
  v_rcp_f32 v181, v181
  v_rcp_f32 v182, v182
  v_rcp_f32 v183, v183
  v_pk_mul_f32 v[176:177], v[176:177], v[20:21]
  v_pk_mul_f32 v[178:179], v[178:179], v[22:23]
  v_pk_mul_f32 v[180:181], v[180:181], v[24:25]
  v_pk_mul_f32 v[182:183], v[182:183], v[26:27]
  v_cvt_pk_bf16_f32 v20, v176, v177
  v_cvt_pk_bf16_f32 v21, v178, v179
  v_cvt_pk_bf16_f32 v22, v180, v181
  v_cvt_pk_bf16_f32 v23, v182, v183
  s_cmp_lg_u32 s54, 0
  s_cbranch_scc0 Lsl_24
  buffer_store_dwordx4 v[20:23], v1, s[16:19], s66 offen offset:0
Lsl_24_b:
.p2align 3
  v_pk_fma_f32 v[176:177], v[150:151], v[132:133], v[156:157] op_sel:[1,0,0] op_sel_hi:[1,1,1] neg_lo:[1,0,0] neg_hi:[1,0,0]
  v_pk_fma_f32 v[178:179], v[150:151], v[134:135], v[158:159] op_sel:[1,0,0] op_sel_hi:[1,1,1] neg_lo:[1,0,0] neg_hi:[1,0,0]
  v_pk_fma_f32 v[180:181], v[150:151], v[136:137], v[160:161] op_sel:[1,0,0] op_sel_hi:[1,1,1] neg_lo:[1,0,0] neg_hi:[1,0,0]
  v_pk_fma_f32 v[182:183], v[150:151], v[138:139], v[162:163] op_sel:[1,0,0] op_sel_hi:[1,1,1] neg_lo:[1,0,0] neg_hi:[1,0,0]
  v_pk_fma_f32 v[48:49], v[150:151], v[48:49], v[176:177] op_sel:[0,0,0] op_sel_hi:[0,1,1]
  v_pk_fma_f32 v[50:51], v[150:151], v[50:51], v[178:179] op_sel:[0,0,0] op_sel_hi:[0,1,1]
  v_pk_fma_f32 v[52:53], v[150:151], v[52:53], v[180:181] op_sel:[0,0,0] op_sel_hi:[0,1,1]
  v_pk_fma_f32 v[54:55], v[150:151], v[54:55], v[182:183] op_sel:[0,0,0] op_sel_hi:[0,1,1]
  v_pk_mul_f32 v[176:177], v[48:49], v[48:49]
  v_pk_mul_f32 v[178:179], v[50:51], v[50:51]
  v_pk_mul_f32 v[180:181], v[52:53], v[52:53]
  v_pk_mul_f32 v[182:183], v[54:55], v[54:55]
  v_pk_fma_f32 v[176:177], v[176:177], v[172:173], v[174:175] op_sel:[0,0,0] op_sel_hi:[1,0,0]
  v_pk_fma_f32 v[178:179], v[178:179], v[172:173], v[174:175] op_sel:[0,0,0] op_sel_hi:[1,0,0]
  v_pk_fma_f32 v[180:181], v[180:181], v[172:173], v[174:175] op_sel:[0,0,0] op_sel_hi:[1,0,0]
  v_pk_fma_f32 v[182:183], v[182:183], v[172:173], v[174:175] op_sel:[0,0,0] op_sel_hi:[1,0,0]
  v_pk_mul_f32 v[176:177], v[176:177], v[48:49]
  v_pk_mul_f32 v[178:179], v[178:179], v[50:51]
  v_pk_mul_f32 v[180:181], v[180:181], v[52:53]
  v_pk_mul_f32 v[182:183], v[182:183], v[54:55]
  v_exp_f32 v176, v176
  v_exp_f32 v177, v177
  v_exp_f32 v178, v178
  v_exp_f32 v179, v179
  v_exp_f32 v180, v180
  v_exp_f32 v181, v181
  v_exp_f32 v182, v182
  v_exp_f32 v183, v183
  v_pk_add_f32 v[176:177], v[176:177], 1.0 op_sel_hi:[1,0]
  v_pk_add_f32 v[178:179], v[178:179], 1.0 op_sel_hi:[1,0]
  v_pk_add_f32 v[180:181], v[180:181], 1.0 op_sel_hi:[1,0]
  v_pk_add_f32 v[182:183], v[182:183], 1.0 op_sel_hi:[1,0]
  v_rcp_f32 v176, v176
  v_rcp_f32 v177, v177
  v_rcp_f32 v178, v178
  v_rcp_f32 v179, v179
  v_rcp_f32 v180, v180
  v_rcp_f32 v181, v181
  v_rcp_f32 v182, v182
  v_rcp_f32 v183, v183
  v_pk_mul_f32 v[176:177], v[176:177], v[48:49]
  v_pk_mul_f32 v[178:179], v[178:179], v[50:51]
  v_pk_mul_f32 v[180:181], v[180:181], v[52:53]
  v_pk_mul_f32 v[182:183], v[182:183], v[54:55]
  v_cvt_pk_bf16_f32 v48, v176, v177
  v_cvt_pk_bf16_f32 v49, v178, v179
  v_cvt_pk_bf16_f32 v50, v180, v181
  v_cvt_pk_bf16_f32 v51, v182, v183
  s_cmp_lg_u32 s54, 0
  s_cbranch_scc0 Lsl_25
  buffer_store_dwordx4 v[48:51], v1, s[16:19], s66 offen offset:1024
Lsl_25_b:
.p2align 3
  v_pk_fma_f32 v[176:177], v[152:153], v[132:133], v[156:157] op_sel:[1,0,0] op_sel_hi:[1,1,1] neg_lo:[1,0,0] neg_hi:[1,0,0]
  v_pk_fma_f32 v[178:179], v[152:153], v[134:135], v[158:159] op_sel:[1,0,0] op_sel_hi:[1,1,1] neg_lo:[1,0,0] neg_hi:[1,0,0]
  v_pk_fma_f32 v[180:181], v[152:153], v[136:137], v[160:161] op_sel:[1,0,0] op_sel_hi:[1,1,1] neg_lo:[1,0,0] neg_hi:[1,0,0]
  v_pk_fma_f32 v[182:183], v[152:153], v[138:139], v[162:163] op_sel:[1,0,0] op_sel_hi:[1,1,1] neg_lo:[1,0,0] neg_hi:[1,0,0]
  v_pk_fma_f32 v[76:77], v[152:153], v[76:77], v[176:177] op_sel:[0,0,0] op_sel_hi:[0,1,1]
  v_pk_fma_f32 v[78:79], v[152:153], v[78:79], v[178:179] op_sel:[0,0,0] op_sel_hi:[0,1,1]
  v_pk_fma_f32 v[80:81], v[152:153], v[80:81], v[180:181] op_sel:[0,0,0] op_sel_hi:[0,1,1]
  v_pk_fma_f32 v[82:83], v[152:153], v[82:83], v[182:183] op_sel:[0,0,0] op_sel_hi:[0,1,1]
  v_pk_mul_f32 v[176:177], v[76:77], v[76:77]
  v_pk_mul_f32 v[178:179], v[78:79], v[78:79]
  v_pk_mul_f32 v[180:181], v[80:81], v[80:81]
  v_pk_mul_f32 v[182:183], v[82:83], v[82:83]
  v_pk_fma_f32 v[176:177], v[176:177], v[172:173], v[174:175] op_sel:[0,0,0] op_sel_hi:[1,0,0]
  v_pk_fma_f32 v[178:179], v[178:179], v[172:173], v[174:175] op_sel:[0,0,0] op_sel_hi:[1,0,0]
  v_pk_fma_f32 v[180:181], v[180:181], v[172:173], v[174:175] op_sel:[0,0,0] op_sel_hi:[1,0,0]
  v_pk_fma_f32 v[182:183], v[182:183], v[172:173], v[174:175] op_sel:[0,0,0] op_sel_hi:[1,0,0]
  v_pk_mul_f32 v[176:177], v[176:177], v[76:77]
  v_pk_mul_f32 v[178:179], v[178:179], v[78:79]
  v_pk_mul_f32 v[180:181], v[180:181], v[80:81]
  v_pk_mul_f32 v[182:183], v[182:183], v[82:83]
  v_exp_f32 v176, v176
  v_exp_f32 v177, v177
  v_exp_f32 v178, v178
  v_exp_f32 v179, v179
  v_exp_f32 v180, v180
  v_exp_f32 v181, v181
  v_exp_f32 v182, v182
  v_exp_f32 v183, v183
  v_pk_add_f32 v[176:177], v[176:177], 1.0 op_sel_hi:[1,0]
  v_pk_add_f32 v[178:179], v[178:179], 1.0 op_sel_hi:[1,0]
  v_pk_add_f32 v[180:181], v[180:181], 1.0 op_sel_hi:[1,0]
  v_pk_add_f32 v[182:183], v[182:183], 1.0 op_sel_hi:[1,0]
  v_rcp_f32 v176, v176
  v_rcp_f32 v177, v177
  v_rcp_f32 v178, v178
  v_rcp_f32 v179, v179
  v_rcp_f32 v180, v180
  v_rcp_f32 v181, v181
  v_rcp_f32 v182, v182
  v_rcp_f32 v183, v183
  v_pk_mul_f32 v[176:177], v[176:177], v[76:77]
  v_pk_mul_f32 v[178:179], v[178:179], v[78:79]
  v_pk_mul_f32 v[180:181], v[180:181], v[80:81]
  v_pk_mul_f32 v[182:183], v[182:183], v[82:83]
  v_cvt_pk_bf16_f32 v76, v176, v177
  v_cvt_pk_bf16_f32 v77, v178, v179
  v_cvt_pk_bf16_f32 v78, v180, v181
  v_cvt_pk_bf16_f32 v79, v182, v183
  s_cmp_lg_u32 s54, 0
  s_cbranch_scc0 Lsl_26
  buffer_store_dwordx4 v[76:79], v1, s[16:19], s66 offen offset:2048
Lsl_26_b:
.p2align 3
  v_pk_fma_f32 v[176:177], v[154:155], v[132:133], v[156:157] op_sel:[1,0,0] op_sel_hi:[1,1,1] neg_lo:[1,0,0] neg_hi:[1,0,0]
  v_pk_fma_f32 v[178:179], v[154:155], v[134:135], v[158:159] op_sel:[1,0,0] op_sel_hi:[1,1,1] neg_lo:[1,0,0] neg_hi:[1,0,0]
  v_pk_fma_f32 v[180:181], v[154:155], v[136:137], v[160:161] op_sel:[1,0,0] op_sel_hi:[1,1,1] neg_lo:[1,0,0] neg_hi:[1,0,0]
  v_pk_fma_f32 v[182:183], v[154:155], v[138:139], v[162:163] op_sel:[1,0,0] op_sel_hi:[1,1,1] neg_lo:[1,0,0] neg_hi:[1,0,0]
  v_pk_fma_f32 v[104:105], v[154:155], v[104:105], v[176:177] op_sel:[0,0,0] op_sel_hi:[0,1,1]
  v_pk_fma_f32 v[106:107], v[154:155], v[106:107], v[178:179] op_sel:[0,0,0] op_sel_hi:[0,1,1]
  v_pk_fma_f32 v[108:109], v[154:155], v[108:109], v[180:181] op_sel:[0,0,0] op_sel_hi:[0,1,1]
  v_pk_fma_f32 v[110:111], v[154:155], v[110:111], v[182:183] op_sel:[0,0,0] op_sel_hi:[0,1,1]
  v_pk_mul_f32 v[176:177], v[104:105], v[104:105]
  v_pk_mul_f32 v[178:179], v[106:107], v[106:107]
  v_pk_mul_f32 v[180:181], v[108:109], v[108:109]
  v_pk_mul_f32 v[182:183], v[110:111], v[110:111]
  v_pk_fma_f32 v[176:177], v[176:177], v[172:173], v[174:175] op_sel:[0,0,0] op_sel_hi:[1,0,0]
  v_pk_fma_f32 v[178:179], v[178:179], v[172:173], v[174:175] op_sel:[0,0,0] op_sel_hi:[1,0,0]
  v_pk_fma_f32 v[180:181], v[180:181], v[172:173], v[174:175] op_sel:[0,0,0] op_sel_hi:[1,0,0]
  v_pk_fma_f32 v[182:183], v[182:183], v[172:173], v[174:175] op_sel:[0,0,0] op_sel_hi:[1,0,0]
  v_pk_mul_f32 v[176:177], v[176:177], v[104:105]
  v_pk_mul_f32 v[178:179], v[178:179], v[106:107]
  v_pk_mul_f32 v[180:181], v[180:181], v[108:109]
  v_pk_mul_f32 v[182:183], v[182:183], v[110:111]
  v_exp_f32 v176, v176
  v_exp_f32 v177, v177
  v_exp_f32 v178, v178
  v_exp_f32 v179, v179
  v_exp_f32 v180, v180
  v_exp_f32 v181, v181
  v_exp_f32 v182, v182
  v_exp_f32 v183, v183
  v_pk_add_f32 v[176:177], v[176:177], 1.0 op_sel_hi:[1,0]
  v_pk_add_f32 v[178:179], v[178:179], 1.0 op_sel_hi:[1,0]
  v_pk_add_f32 v[180:181], v[180:181], 1.0 op_sel_hi:[1,0]
  v_pk_add_f32 v[182:183], v[182:183], 1.0 op_sel_hi:[1,0]
  v_rcp_f32 v176, v176
  v_rcp_f32 v177, v177
  v_rcp_f32 v178, v178
  v_rcp_f32 v179, v179
  v_rcp_f32 v180, v180
  v_rcp_f32 v181, v181
  v_rcp_f32 v182, v182
  v_rcp_f32 v183, v183
  v_pk_mul_f32 v[176:177], v[176:177], v[104:105]
  v_pk_mul_f32 v[178:179], v[178:179], v[106:107]
  v_pk_mul_f32 v[180:181], v[180:181], v[108:109]
  v_pk_mul_f32 v[182:183], v[182:183], v[110:111]
  v_cvt_pk_bf16_f32 v104, v176, v177
  v_cvt_pk_bf16_f32 v105, v178, v179
  v_cvt_pk_bf16_f32 v106, v180, v181
  v_cvt_pk_bf16_f32 v107, v182, v183
  s_cmp_lg_u32 s54, 0
  s_cbranch_scc0 Lsl_27
  buffer_store_dwordx4 v[104:107], v1, s[16:19], s66 offen offset:3072
Lsl_27_b:
.p2align 3
  v_pk_fma_f32 v[176:177], v[148:149], v[140:141], v[164:165] op_sel:[1,0,0] op_sel_hi:[1,1,1] neg_lo:[1,0,0] neg_hi:[1,0,0]
  v_pk_fma_f32 v[178:179], v[148:149], v[142:143], v[166:167] op_sel:[1,0,0] op_sel_hi:[1,1,1] neg_lo:[1,0,0] neg_hi:[1,0,0]
  v_pk_fma_f32 v[180:181], v[148:149], v[144:145], v[168:169] op_sel:[1,0,0] op_sel_hi:[1,1,1] neg_lo:[1,0,0] neg_hi:[1,0,0]
  v_pk_fma_f32 v[182:183], v[148:149], v[146:147], v[170:171] op_sel:[1,0,0] op_sel_hi:[1,1,1] neg_lo:[1,0,0] neg_hi:[1,0,0]
  v_pk_fma_f32 v[28:29], v[148:149], v[28:29], v[176:177] op_sel:[0,0,0] op_sel_hi:[0,1,1]
  v_pk_fma_f32 v[30:31], v[148:149], v[30:31], v[178:179] op_sel:[0,0,0] op_sel_hi:[0,1,1]
  v_pk_fma_f32 v[32:33], v[148:149], v[32:33], v[180:181] op_sel:[0,0,0] op_sel_hi:[0,1,1]
  v_pk_fma_f32 v[34:35], v[148:149], v[34:35], v[182:183] op_sel:[0,0,0] op_sel_hi:[0,1,1]
  v_pk_mul_f32 v[176:177], v[28:29], v[28:29]
  v_pk_mul_f32 v[178:179], v[30:31], v[30:31]
  v_pk_mul_f32 v[180:181], v[32:33], v[32:33]
  v_pk_mul_f32 v[182:183], v[34:35], v[34:35]
  v_pk_fma_f32 v[176:177], v[176:177], v[172:173], v[174:175] op_sel:[0,0,0] op_sel_hi:[1,0,0]
  v_pk_fma_f32 v[178:179], v[178:179], v[172:173], v[174:175] op_sel:[0,0,0] op_sel_hi:[1,0,0]
  v_pk_fma_f32 v[180:181], v[180:181], v[172:173], v[174:175] op_sel:[0,0,0] op_sel_hi:[1,0,0]
  v_pk_fma_f32 v[182:183], v[182:183], v[172:173], v[174:175] op_sel:[0,0,0] op_sel_hi:[1,0,0]
  v_pk_mul_f32 v[176:177], v[176:177], v[28:29]
  v_pk_mul_f32 v[178:179], v[178:179], v[30:31]
  v_pk_mul_f32 v[180:181], v[180:181], v[32:33]
  v_pk_mul_f32 v[182:183], v[182:183], v[34:35]
  v_exp_f32 v176, v176
  v_exp_f32 v177, v177
  v_exp_f32 v178, v178
  v_exp_f32 v179, v179
  v_exp_f32 v180, v180
  v_exp_f32 v181, v181
  v_exp_f32 v182, v182
  v_exp_f32 v183, v183
  v_pk_add_f32 v[176:177], v[176:177], 1.0 op_sel_hi:[1,0]
  v_pk_add_f32 v[178:179], v[178:179], 1.0 op_sel_hi:[1,0]
  v_pk_add_f32 v[180:181], v[180:181], 1.0 op_sel_hi:[1,0]
  v_pk_add_f32 v[182:183], v[182:183], 1.0 op_sel_hi:[1,0]
  v_rcp_f32 v176, v176
  v_rcp_f32 v177, v177
  v_rcp_f32 v178, v178
  v_rcp_f32 v179, v179
  v_rcp_f32 v180, v180
  v_rcp_f32 v181, v181
  v_rcp_f32 v182, v182
  v_rcp_f32 v183, v183
  v_pk_mul_f32 v[176:177], v[176:177], v[28:29]
  v_pk_mul_f32 v[178:179], v[178:179], v[30:31]
  v_pk_mul_f32 v[180:181], v[180:181], v[32:33]
  v_pk_mul_f32 v[182:183], v[182:183], v[34:35]
  v_cvt_pk_bf16_f32 v28, v176, v177
  v_cvt_pk_bf16_f32 v29, v178, v179
  v_cvt_pk_bf16_f32 v30, v180, v181
  v_cvt_pk_bf16_f32 v31, v182, v183
  s_cmp_lg_u32 s54, 0
  s_cbranch_scc0 Lsl_28
  buffer_store_dwordx4 v[28:31], v1, s[16:19], s67 offen offset:0
Lsl_28_b:
  s_lshl_b32 s3, s58, 1
  s_add_u32 s3, s3, s63
  s_mul_i32 s3, s3, 240
  s_lshr_b32 s80, s66, 10
  s_add_u32 s3, s3, s80
  s_add_u32 s3, s3, 0xd14000
  v_mov_b32 v4, s62
  v_mov_b32 v5, 0
  s_mov_b64 exec, 1
  s_waitcnt vmcnt(1)
  s_cmp_lg_u32 s54, 0
  s_cbranch_scc0 Lsl_29
  buffer_store_dword v4, v5, s[16:19], s3 offen
Lsl_29_b:
  s_mov_b64 exec, -1
  s_nop 0
.p2align 3
  v_pk_fma_f32 v[176:177], v[150:151], v[140:141], v[164:165] op_sel:[1,0,0] op_sel_hi:[1,1,1] neg_lo:[1,0,0] neg_hi:[1,0,0]
  v_pk_fma_f32 v[178:179], v[150:151], v[142:143], v[166:167] op_sel:[1,0,0] op_sel_hi:[1,1,1] neg_lo:[1,0,0] neg_hi:[1,0,0]
  v_pk_fma_f32 v[180:181], v[150:151], v[144:145], v[168:169] op_sel:[1,0,0] op_sel_hi:[1,1,1] neg_lo:[1,0,0] neg_hi:[1,0,0]
  v_pk_fma_f32 v[182:183], v[150:151], v[146:147], v[170:171] op_sel:[1,0,0] op_sel_hi:[1,1,1] neg_lo:[1,0,0] neg_hi:[1,0,0]
  v_pk_fma_f32 v[56:57], v[150:151], v[56:57], v[176:177] op_sel:[0,0,0] op_sel_hi:[0,1,1]
  v_pk_fma_f32 v[58:59], v[150:151], v[58:59], v[178:179] op_sel:[0,0,0] op_sel_hi:[0,1,1]
  v_pk_fma_f32 v[60:61], v[150:151], v[60:61], v[180:181] op_sel:[0,0,0] op_sel_hi:[0,1,1]
  v_pk_fma_f32 v[62:63], v[150:151], v[62:63], v[182:183] op_sel:[0,0,0] op_sel_hi:[0,1,1]
  v_pk_mul_f32 v[176:177], v[56:57], v[56:57]
  v_pk_mul_f32 v[178:179], v[58:59], v[58:59]
  v_pk_mul_f32 v[180:181], v[60:61], v[60:61]
  v_pk_mul_f32 v[182:183], v[62:63], v[62:63]
  v_pk_fma_f32 v[176:177], v[176:177], v[172:173], v[174:175] op_sel:[0,0,0] op_sel_hi:[1,0,0]
  v_pk_fma_f32 v[178:179], v[178:179], v[172:173], v[174:175] op_sel:[0,0,0] op_sel_hi:[1,0,0]
  v_pk_fma_f32 v[180:181], v[180:181], v[172:173], v[174:175] op_sel:[0,0,0] op_sel_hi:[1,0,0]
  v_pk_fma_f32 v[182:183], v[182:183], v[172:173], v[174:175] op_sel:[0,0,0] op_sel_hi:[1,0,0]
  v_pk_mul_f32 v[176:177], v[176:177], v[56:57]
  v_pk_mul_f32 v[178:179], v[178:179], v[58:59]
  v_pk_mul_f32 v[180:181], v[180:181], v[60:61]
  v_pk_mul_f32 v[182:183], v[182:183], v[62:63]
  v_exp_f32 v176, v176
  v_exp_f32 v177, v177
  v_exp_f32 v178, v178
  v_exp_f32 v179, v179
  v_exp_f32 v180, v180
  v_exp_f32 v181, v181
  v_exp_f32 v182, v182
  v_exp_f32 v183, v183
  v_pk_add_f32 v[176:177], v[176:177], 1.0 op_sel_hi:[1,0]
  v_pk_add_f32 v[178:179], v[178:179], 1.0 op_sel_hi:[1,0]
  v_pk_add_f32 v[180:181], v[180:181], 1.0 op_sel_hi:[1,0]
  v_pk_add_f32 v[182:183], v[182:183], 1.0 op_sel_hi:[1,0]
  v_rcp_f32 v176, v176
  v_rcp_f32 v177, v177
  v_rcp_f32 v178, v178
  v_rcp_f32 v179, v179
  v_rcp_f32 v180, v180
  v_rcp_f32 v181, v181
  v_rcp_f32 v182, v182
  v_rcp_f32 v183, v183
  v_pk_mul_f32 v[176:177], v[176:177], v[56:57]
  v_pk_mul_f32 v[178:179], v[178:179], v[58:59]
  v_pk_mul_f32 v[180:181], v[180:181], v[60:61]
  v_pk_mul_f32 v[182:183], v[182:183], v[62:63]
  v_cvt_pk_bf16_f32 v56, v176, v177
  v_cvt_pk_bf16_f32 v57, v178, v179
  v_cvt_pk_bf16_f32 v58, v180, v181
  v_cvt_pk_bf16_f32 v59, v182, v183
  s_cmp_lg_u32 s54, 0
  s_cbranch_scc0 Lsl_30
  buffer_store_dwordx4 v[56:59], v1, s[16:19], s67 offen offset:1024
Lsl_30_b:
.p2align 3
  v_pk_fma_f32 v[176:177], v[152:153], v[140:141], v[164:165] op_sel:[1,0,0] op_sel_hi:[1,1,1] neg_lo:[1,0,0] neg_hi:[1,0,0]
  v_pk_fma_f32 v[178:179], v[152:153], v[142:143], v[166:167] op_sel:[1,0,0] op_sel_hi:[1,1,1] neg_lo:[1,0,0] neg_hi:[1,0,0]
  v_pk_fma_f32 v[180:181], v[152:153], v[144:145], v[168:169] op_sel:[1,0,0] op_sel_hi:[1,1,1] neg_lo:[1,0,0] neg_hi:[1,0,0]
  v_pk_fma_f32 v[182:183], v[152:153], v[146:147], v[170:171] op_sel:[1,0,0] op_sel_hi:[1,1,1] neg_lo:[1,0,0] neg_hi:[1,0,0]
  v_pk_fma_f32 v[84:85], v[152:153], v[84:85], v[176:177] op_sel:[0,0,0] op_sel_hi:[0,1,1]
  v_pk_fma_f32 v[86:87], v[152:153], v[86:87], v[178:179] op_sel:[0,0,0] op_sel_hi:[0,1,1]
  v_pk_fma_f32 v[88:89], v[152:153], v[88:89], v[180:181] op_sel:[0,0,0] op_sel_hi:[0,1,1]
  v_pk_fma_f32 v[90:91], v[152:153], v[90:91], v[182:183] op_sel:[0,0,0] op_sel_hi:[0,1,1]
  v_pk_mul_f32 v[176:177], v[84:85], v[84:85]
  v_pk_mul_f32 v[178:179], v[86:87], v[86:87]
  v_pk_mul_f32 v[180:181], v[88:89], v[88:89]
  v_pk_mul_f32 v[182:183], v[90:91], v[90:91]
  v_pk_fma_f32 v[176:177], v[176:177], v[172:173], v[174:175] op_sel:[0,0,0] op_sel_hi:[1,0,0]
  v_pk_fma_f32 v[178:179], v[178:179], v[172:173], v[174:175] op_sel:[0,0,0] op_sel_hi:[1,0,0]
  v_pk_fma_f32 v[180:181], v[180:181], v[172:173], v[174:175] op_sel:[0,0,0] op_sel_hi:[1,0,0]
  v_pk_fma_f32 v[182:183], v[182:183], v[172:173], v[174:175] op_sel:[0,0,0] op_sel_hi:[1,0,0]
  v_pk_mul_f32 v[176:177], v[176:177], v[84:85]
  v_pk_mul_f32 v[178:179], v[178:179], v[86:87]
  v_pk_mul_f32 v[180:181], v[180:181], v[88:89]
  v_pk_mul_f32 v[182:183], v[182:183], v[90:91]
  v_exp_f32 v176, v176
  v_exp_f32 v177, v177
  v_exp_f32 v178, v178
  v_exp_f32 v179, v179
  v_exp_f32 v180, v180
  v_exp_f32 v181, v181
  v_exp_f32 v182, v182
  v_exp_f32 v183, v183
  v_pk_add_f32 v[176:177], v[176:177], 1.0 op_sel_hi:[1,0]
  v_pk_add_f32 v[178:179], v[178:179], 1.0 op_sel_hi:[1,0]
  v_pk_add_f32 v[180:181], v[180:181], 1.0 op_sel_hi:[1,0]
  v_pk_add_f32 v[182:183], v[182:183], 1.0 op_sel_hi:[1,0]
  v_rcp_f32 v176, v176
  v_rcp_f32 v177, v177
  v_rcp_f32 v178, v178
  v_rcp_f32 v179, v179
  v_rcp_f32 v180, v180
  v_rcp_f32 v181, v181
  v_rcp_f32 v182, v182
  v_rcp_f32 v183, v183
  v_pk_mul_f32 v[176:177], v[176:177], v[84:85]
  v_pk_mul_f32 v[178:179], v[178:179], v[86:87]
  v_pk_mul_f32 v[180:181], v[180:181], v[88:89]
  v_pk_mul_f32 v[182:183], v[182:183], v[90:91]
  v_cvt_pk_bf16_f32 v84, v176, v177
  v_cvt_pk_bf16_f32 v85, v178, v179
  v_cvt_pk_bf16_f32 v86, v180, v181
  v_cvt_pk_bf16_f32 v87, v182, v183
  s_cmp_lg_u32 s54, 0
  s_cbranch_scc0 Lsl_31
  buffer_store_dwordx4 v[84:87], v1, s[16:19], s67 offen offset:2048
Lsl_31_b:
.p2align 3
  v_pk_fma_f32 v[176:177], v[154:155], v[140:141], v[164:165] op_sel:[1,0,0] op_sel_hi:[1,1,1] neg_lo:[1,0,0] neg_hi:[1,0,0]
  v_pk_fma_f32 v[178:179], v[154:155], v[142:143], v[166:167] op_sel:[1,0,0] op_sel_hi:[1,1,1] neg_lo:[1,0,0] neg_hi:[1,0,0]
  v_pk_fma_f32 v[180:181], v[154:155], v[144:145], v[168:169] op_sel:[1,0,0] op_sel_hi:[1,1,1] neg_lo:[1,0,0] neg_hi:[1,0,0]
  v_pk_fma_f32 v[182:183], v[154:155], v[146:147], v[170:171] op_sel:[1,0,0] op_sel_hi:[1,1,1] neg_lo:[1,0,0] neg_hi:[1,0,0]
  v_pk_fma_f32 v[112:113], v[154:155], v[112:113], v[176:177] op_sel:[0,0,0] op_sel_hi:[0,1,1]
  v_pk_fma_f32 v[114:115], v[154:155], v[114:115], v[178:179] op_sel:[0,0,0] op_sel_hi:[0,1,1]
  v_pk_fma_f32 v[116:117], v[154:155], v[116:117], v[180:181] op_sel:[0,0,0] op_sel_hi:[0,1,1]
  v_pk_fma_f32 v[118:119], v[154:155], v[118:119], v[182:183] op_sel:[0,0,0] op_sel_hi:[0,1,1]
  v_pk_mul_f32 v[176:177], v[112:113], v[112:113]
  v_pk_mul_f32 v[178:179], v[114:115], v[114:115]
  v_pk_mul_f32 v[180:181], v[116:117], v[116:117]
  v_pk_mul_f32 v[182:183], v[118:119], v[118:119]
  v_pk_fma_f32 v[176:177], v[176:177], v[172:173], v[174:175] op_sel:[0,0,0] op_sel_hi:[1,0,0]
  v_pk_fma_f32 v[178:179], v[178:179], v[172:173], v[174:175] op_sel:[0,0,0] op_sel_hi:[1,0,0]
  v_pk_fma_f32 v[180:181], v[180:181], v[172:173], v[174:175] op_sel:[0,0,0] op_sel_hi:[1,0,0]
  v_pk_fma_f32 v[182:183], v[182:183], v[172:173], v[174:175] op_sel:[0,0,0] op_sel_hi:[1,0,0]
  v_pk_mul_f32 v[176:177], v[176:177], v[112:113]
  v_pk_mul_f32 v[178:179], v[178:179], v[114:115]
  v_pk_mul_f32 v[180:181], v[180:181], v[116:117]
  v_pk_mul_f32 v[182:183], v[182:183], v[118:119]
  v_exp_f32 v176, v176
  v_exp_f32 v177, v177
  v_exp_f32 v178, v178
  v_exp_f32 v179, v179
  v_exp_f32 v180, v180
  v_exp_f32 v181, v181
  v_exp_f32 v182, v182
  v_exp_f32 v183, v183
  v_pk_add_f32 v[176:177], v[176:177], 1.0 op_sel_hi:[1,0]
  v_pk_add_f32 v[178:179], v[178:179], 1.0 op_sel_hi:[1,0]
  v_pk_add_f32 v[180:181], v[180:181], 1.0 op_sel_hi:[1,0]
  v_pk_add_f32 v[182:183], v[182:183], 1.0 op_sel_hi:[1,0]
  v_rcp_f32 v176, v176
  v_rcp_f32 v177, v177
  v_rcp_f32 v178, v178
  v_rcp_f32 v179, v179
  v_rcp_f32 v180, v180
  v_rcp_f32 v181, v181
  v_rcp_f32 v182, v182
  v_rcp_f32 v183, v183
  v_pk_mul_f32 v[176:177], v[176:177], v[112:113]
  v_pk_mul_f32 v[178:179], v[178:179], v[114:115]
  v_pk_mul_f32 v[180:181], v[180:181], v[116:117]
  v_pk_mul_f32 v[182:183], v[182:183], v[118:119]
  v_cvt_pk_bf16_f32 v112, v176, v177
  v_cvt_pk_bf16_f32 v113, v178, v179
  v_cvt_pk_bf16_f32 v114, v180, v181
  v_cvt_pk_bf16_f32 v115, v182, v183
  s_cmp_lg_u32 s54, 0
  s_cbranch_scc0 Lsl_32
  buffer_store_dwordx4 v[112:115], v1, s[16:19], s67 offen offset:3072
Lsl_32_b:
.p2align 3
  v_pk_fma_f32 v[176:177], v[148:149], v[120:121], v[174:175] op_sel:[1,0,1] op_sel_hi:[1,1,1] neg_lo:[1,0,0] neg_hi:[1,0,0]
  v_pk_fma_f32 v[178:179], v[148:149], v[122:123], v[174:175] op_sel:[1,0,1] op_sel_hi:[1,1,1] neg_lo:[1,0,0] neg_hi:[1,0,0]
  v_pk_fma_f32 v[180:181], v[148:149], v[124:125], v[174:175] op_sel:[1,0,1] op_sel_hi:[1,1,1] neg_lo:[1,0,0] neg_hi:[1,0,0]
  v_pk_fma_f32 v[182:183], v[148:149], v[126:127], v[174:175] op_sel:[1,0,1] op_sel_hi:[1,1,1] neg_lo:[1,0,0] neg_hi:[1,0,0]
  v_pk_fma_f32 v[184:185], v[148:149], v[128:129], v[174:175] op_sel:[1,0,1] op_sel_hi:[1,1,1] neg_lo:[1,0,0] neg_hi:[1,0,0]
  v_pk_fma_f32 v[186:187], v[148:149], v[130:131], v[174:175] op_sel:[1,0,1] op_sel_hi:[1,1,1] neg_lo:[1,0,0] neg_hi:[1,0,0]
  v_pk_fma_f32 v[8:9], v[148:149], v[8:9], v[176:177] op_sel:[0,0,0] op_sel_hi:[0,1,1]
  v_pk_fma_f32 v[10:11], v[148:149], v[10:11], v[178:179] op_sel:[0,0,0] op_sel_hi:[0,1,1]
  v_pk_fma_f32 v[12:13], v[148:149], v[12:13], v[180:181] op_sel:[0,0,0] op_sel_hi:[0,1,1]
  v_pk_fma_f32 v[14:15], v[148:149], v[14:15], v[182:183] op_sel:[0,0,0] op_sel_hi:[0,1,1]
  v_pk_fma_f32 v[16:17], v[148:149], v[16:17], v[184:185] op_sel:[0,0,0] op_sel_hi:[0,1,1]
  v_pk_fma_f32 v[18:19], v[148:149], v[18:19], v[186:187] op_sel:[0,0,0] op_sel_hi:[0,1,1]
  v_pk_mul_f32 v[176:177], v[172:173], v[8:9] op_sel:[1,0] op_sel_hi:[1,1]
  v_pk_mul_f32 v[178:179], v[172:173], v[10:11] op_sel:[1,0] op_sel_hi:[1,1]
  v_pk_mul_f32 v[180:181], v[172:173], v[12:13] op_sel:[1,0] op_sel_hi:[1,1]
  v_pk_mul_f32 v[182:183], v[172:173], v[14:15] op_sel:[1,0] op_sel_hi:[1,1]
  v_pk_mul_f32 v[184:185], v[172:173], v[16:17] op_sel:[1,0] op_sel_hi:[1,1]
  v_pk_mul_f32 v[186:187], v[172:173], v[18:19] op_sel:[1,0] op_sel_hi:[1,1]
  v_exp_f32_e64 v176, v176 clamp
  v_exp_f32_e64 v177, v177 clamp
  v_exp_f32_e64 v178, v178 clamp
  v_exp_f32_e64 v179, v179 clamp
  v_exp_f32_e64 v180, v180 clamp
  v_exp_f32_e64 v181, v181 clamp
  v_exp_f32_e64 v182, v182 clamp
  v_exp_f32_e64 v183, v183 clamp
  v_exp_f32_e64 v184, v184 clamp
  v_exp_f32_e64 v185, v185 clamp
  v_exp_f32_e64 v186, v186 clamp
  v_exp_f32_e64 v187, v187 clamp
  v_max_f32 v8, v8, v175
  v_max_f32 v9, v9, v175
  v_max_f32 v10, v10, v175
  v_max_f32 v11, v11, v175
  v_max_f32 v12, v12, v175
  v_max_f32 v13, v13, v175
  v_max_f32 v14, v14, v175
  v_max_f32 v15, v15, v175
  v_max_f32 v16, v16, v175
  v_max_f32 v17, v17, v175
  v_max_f32 v18, v18, v175
  v_max_f32 v19, v19, v175
  v_pk_add_f32 v[8:9], v[8:9], v[176:177]
  v_pk_add_f32 v[10:11], v[10:11], v[178:179]
  v_pk_add_f32 v[12:13], v[12:13], v[180:181]
  v_pk_add_f32 v[14:15], v[14:15], v[182:183]
  v_pk_add_f32 v[16:17], v[16:17], v[184:185]
  v_pk_add_f32 v[18:19], v[18:19], v[186:187]
  v_cvt_pk_bf16_f32 v224, v8, v9
  v_cvt_pk_bf16_f32 v225, v10, v11
  v_cvt_pk_bf16_f32 v226, v12, v13
  v_cvt_pk_bf16_f32 v227, v14, v15
  v_cvt_pk_bf16_f32 v228, v16, v17
  v_cvt_pk_bf16_f32 v229, v18, v19
  s_lshl_b32 s3, s58, 1
  s_add_u32 s3, s3, s63
  s_mul_i32 s3, s3, 240
  s_lshr_b32 s80, s67, 10
  s_add_u32 s3, s3, s80
  s_add_u32 s3, s3, 0xd14000
  v_mov_b32 v4, s62
  v_mov_b32 v5, 0
  s_mov_b64 exec, 1
  s_waitcnt vmcnt(0)
  s_cmp_lg_u32 s54, 0
  s_cbranch_scc0 Lsl_33
  buffer_store_dword v4, v5, s[16:19], s3 offen
Lsl_33_b:
  s_mov_b64 exec, -1
  s_nop 0
  s_add_u32 s3, s39, 245760
  buffer_load_dwordx4 v[20:23], v1, s[16:19], s3 offen offset:0 sc1
  buffer_load_dwordx4 v[24:27], v1, s[16:19], s3 offen offset:1024 sc1
  buffer_load_dwordx4 v[48:51], v1, s[16:19], s3 offen offset:2048 sc1
  buffer_load_dwordx4 v[52:55], v1, s[16:19], s3 offen offset:3072 sc1
  buffer_load_dwordx4 v[76:79], v2, s[16:19], s3 offen sc1
.p2align 3
  v_pk_fma_f32 v[176:177], v[150:151], v[120:121], v[174:175] op_sel:[1,0,1] op_sel_hi:[1,1,1] neg_lo:[1,0,0] neg_hi:[1,0,0]
  v_pk_fma_f32 v[178:179], v[150:151], v[122:123], v[174:175] op_sel:[1,0,1] op_sel_hi:[1,1,1] neg_lo:[1,0,0] neg_hi:[1,0,0]
  v_pk_fma_f32 v[180:181], v[150:151], v[124:125], v[174:175] op_sel:[1,0,1] op_sel_hi:[1,1,1] neg_lo:[1,0,0] neg_hi:[1,0,0]
  v_pk_fma_f32 v[182:183], v[150:151], v[126:127], v[174:175] op_sel:[1,0,1] op_sel_hi:[1,1,1] neg_lo:[1,0,0] neg_hi:[1,0,0]
  v_pk_fma_f32 v[184:185], v[150:151], v[128:129], v[174:175] op_sel:[1,0,1] op_sel_hi:[1,1,1] neg_lo:[1,0,0] neg_hi:[1,0,0]
  v_pk_fma_f32 v[186:187], v[150:151], v[130:131], v[174:175] op_sel:[1,0,1] op_sel_hi:[1,1,1] neg_lo:[1,0,0] neg_hi:[1,0,0]
  v_pk_fma_f32 v[36:37], v[150:151], v[36:37], v[176:177] op_sel:[0,0,0] op_sel_hi:[0,1,1]
  v_pk_fma_f32 v[38:39], v[150:151], v[38:39], v[178:179] op_sel:[0,0,0] op_sel_hi:[0,1,1]
  v_pk_fma_f32 v[40:41], v[150:151], v[40:41], v[180:181] op_sel:[0,0,0] op_sel_hi:[0,1,1]
  v_pk_fma_f32 v[42:43], v[150:151], v[42:43], v[182:183] op_sel:[0,0,0] op_sel_hi:[0,1,1]
  v_pk_fma_f32 v[44:45], v[150:151], v[44:45], v[184:185] op_sel:[0,0,0] op_sel_hi:[0,1,1]
  v_pk_fma_f32 v[46:47], v[150:151], v[46:47], v[186:187] op_sel:[0,0,0] op_sel_hi:[0,1,1]
  v_pk_mul_f32 v[176:177], v[172:173], v[36:37] op_sel:[1,0] op_sel_hi:[1,1]
  v_pk_mul_f32 v[178:179], v[172:173], v[38:39] op_sel:[1,0] op_sel_hi:[1,1]
  v_pk_mul_f32 v[180:181], v[172:173], v[40:41] op_sel:[1,0] op_sel_hi:[1,1]
  v_pk_mul_f32 v[182:183], v[172:173], v[42:43] op_sel:[1,0] op_sel_hi:[1,1]
  v_pk_mul_f32 v[184:185], v[172:173], v[44:45] op_sel:[1,0] op_sel_hi:[1,1]
  v_pk_mul_f32 v[186:187], v[172:173], v[46:47] op_sel:[1,0] op_sel_hi:[1,1]
  v_exp_f32_e64 v176, v176 clamp
  v_exp_f32_e64 v177, v177 clamp
  v_exp_f32_e64 v178, v178 clamp
  v_exp_f32_e64 v179, v179 clamp
  v_exp_f32_e64 v180, v180 clamp
  v_exp_f32_e64 v181, v181 clamp
  v_exp_f32_e64 v182, v182 clamp
  v_exp_f32_e64 v183, v183 clamp
  v_exp_f32_e64 v184, v184 clamp
  v_exp_f32_e64 v185, v185 clamp
  v_exp_f32_e64 v186, v186 clamp
  v_exp_f32_e64 v187, v187 clamp
  v_max_f32 v36, v36, v175
  v_max_f32 v37, v37, v175
  v_max_f32 v38, v38, v175
  v_max_f32 v39, v39, v175
  v_max_f32 v40, v40, v175
  v_max_f32 v41, v41, v175
  v_max_f32 v42, v42, v175
  v_max_f32 v43, v43, v175
  v_max_f32 v44, v44, v175
  v_max_f32 v45, v45, v175
  v_max_f32 v46, v46, v175
  v_max_f32 v47, v47, v175
  v_pk_add_f32 v[36:37], v[36:37], v[176:177]
  v_pk_add_f32 v[38:39], v[38:39], v[178:179]
  v_pk_add_f32 v[40:41], v[40:41], v[180:181]
  v_pk_add_f32 v[42:43], v[42:43], v[182:183]
  v_pk_add_f32 v[44:45], v[44:45], v[184:185]
  v_pk_add_f32 v[46:47], v[46:47], v[186:187]
  v_cvt_pk_bf16_f32 v230, v36, v37
  v_cvt_pk_bf16_f32 v231, v38, v39
  v_cvt_pk_bf16_f32 v232, v40, v41
  v_cvt_pk_bf16_f32 v233, v42, v43
  v_cvt_pk_bf16_f32 v234, v44, v45
  v_cvt_pk_bf16_f32 v235, v46, v47
  s_add_u32 s3, s39, 286720
  buffer_load_dwordx4 v[80:83], v1, s[16:19], s3 offen offset:0 sc1
  buffer_load_dwordx4 v[104:107], v1, s[16:19], s3 offen offset:1024 sc1
  buffer_load_dwordx4 v[108:111], v1, s[16:19], s3 offen offset:2048 sc1
  buffer_load_dwordx4 v[216:219], v1, s[16:19], s3 offen offset:3072 sc1
  buffer_load_dwordx4 v[220:223], v2, s[16:19], s3 offen sc1
.p2align 3
  v_pk_fma_f32 v[176:177], v[152:153], v[120:121], v[174:175] op_sel:[1,0,1] op_sel_hi:[1,1,1] neg_lo:[1,0,0] neg_hi:[1,0,0]
  v_pk_fma_f32 v[178:179], v[152:153], v[122:123], v[174:175] op_sel:[1,0,1] op_sel_hi:[1,1,1] neg_lo:[1,0,0] neg_hi:[1,0,0]
  v_pk_fma_f32 v[180:181], v[152:153], v[124:125], v[174:175] op_sel:[1,0,1] op_sel_hi:[1,1,1] neg_lo:[1,0,0] neg_hi:[1,0,0]
  v_pk_fma_f32 v[182:183], v[152:153], v[126:127], v[174:175] op_sel:[1,0,1] op_sel_hi:[1,1,1] neg_lo:[1,0,0] neg_hi:[1,0,0]
  v_pk_fma_f32 v[184:185], v[152:153], v[128:129], v[174:175] op_sel:[1,0,1] op_sel_hi:[1,1,1] neg_lo:[1,0,0] neg_hi:[1,0,0]
  v_pk_fma_f32 v[186:187], v[152:153], v[130:131], v[174:175] op_sel:[1,0,1] op_sel_hi:[1,1,1] neg_lo:[1,0,0] neg_hi:[1,0,0]
  v_pk_fma_f32 v[64:65], v[152:153], v[64:65], v[176:177] op_sel:[0,0,0] op_sel_hi:[0,1,1]
  v_pk_fma_f32 v[66:67], v[152:153], v[66:67], v[178:179] op_sel:[0,0,0] op_sel_hi:[0,1,1]
  v_pk_fma_f32 v[68:69], v[152:153], v[68:69], v[180:181] op_sel:[0,0,0] op_sel_hi:[0,1,1]
  v_pk_fma_f32 v[70:71], v[152:153], v[70:71], v[182:183] op_sel:[0,0,0] op_sel_hi:[0,1,1]
  v_pk_fma_f32 v[72:73], v[152:153], v[72:73], v[184:185] op_sel:[0,0,0] op_sel_hi:[0,1,1]
  v_pk_fma_f32 v[74:75], v[152:153], v[74:75], v[186:187] op_sel:[0,0,0] op_sel_hi:[0,1,1]
  v_pk_mul_f32 v[176:177], v[172:173], v[64:65] op_sel:[1,0] op_sel_hi:[1,1]
  v_pk_mul_f32 v[178:179], v[172:173], v[66:67] op_sel:[1,0] op_sel_hi:[1,1]
  v_pk_mul_f32 v[180:181], v[172:173], v[68:69] op_sel:[1,0] op_sel_hi:[1,1]
  v_pk_mul_f32 v[182:183], v[172:173], v[70:71] op_sel:[1,0] op_sel_hi:[1,1]
  v_pk_mul_f32 v[184:185], v[172:173], v[72:73] op_sel:[1,0] op_sel_hi:[1,1]
  v_pk_mul_f32 v[186:187], v[172:173], v[74:75] op_sel:[1,0] op_sel_hi:[1,1]
  v_exp_f32_e64 v176, v176 clamp
  v_exp_f32_e64 v177, v177 clamp
  v_exp_f32_e64 v178, v178 clamp
  v_exp_f32_e64 v179, v179 clamp
  v_exp_f32_e64 v180, v180 clamp
  v_exp_f32_e64 v181, v181 clamp
  v_exp_f32_e64 v182, v182 clamp
  v_exp_f32_e64 v183, v183 clamp
  v_exp_f32_e64 v184, v184 clamp
  v_exp_f32_e64 v185, v185 clamp
  v_exp_f32_e64 v186, v186 clamp
  v_exp_f32_e64 v187, v187 clamp
  v_max_f32 v64, v64, v175
  v_max_f32 v65, v65, v175
  v_max_f32 v66, v66, v175
  v_max_f32 v67, v67, v175
  v_max_f32 v68, v68, v175
  v_max_f32 v69, v69, v175
  v_max_f32 v70, v70, v175
  v_max_f32 v71, v71, v175
  v_max_f32 v72, v72, v175
  v_max_f32 v73, v73, v175
  v_max_f32 v74, v74, v175
  v_max_f32 v75, v75, v175
  v_pk_add_f32 v[64:65], v[64:65], v[176:177]
  v_pk_add_f32 v[66:67], v[66:67], v[178:179]
  v_pk_add_f32 v[68:69], v[68:69], v[180:181]
  v_pk_add_f32 v[70:71], v[70:71], v[182:183]
  v_pk_add_f32 v[72:73], v[72:73], v[184:185]
  v_pk_add_f32 v[74:75], v[74:75], v[186:187]
  v_cvt_pk_bf16_f32 v236, v64, v65
  v_cvt_pk_bf16_f32 v237, v66, v67
  v_cvt_pk_bf16_f32 v238, v68, v69
  v_cvt_pk_bf16_f32 v239, v70, v71
  v_cvt_pk_bf16_f32 v240, v72, v73
  v_cvt_pk_bf16_f32 v241, v74, v75
.p2align 3
  v_pk_fma_f32 v[176:177], v[154:155], v[120:121], v[174:175] op_sel:[1,0,1] op_sel_hi:[1,1,1] neg_lo:[1,0,0] neg_hi:[1,0,0]
  v_pk_fma_f32 v[178:179], v[154:155], v[122:123], v[174:175] op_sel:[1,0,1] op_sel_hi:[1,1,1] neg_lo:[1,0,0] neg_hi:[1,0,0]
  v_pk_fma_f32 v[180:181], v[154:155], v[124:125], v[174:175] op_sel:[1,0,1] op_sel_hi:[1,1,1] neg_lo:[1,0,0] neg_hi:[1,0,0]
  v_pk_fma_f32 v[182:183], v[154:155], v[126:127], v[174:175] op_sel:[1,0,1] op_sel_hi:[1,1,1] neg_lo:[1,0,0] neg_hi:[1,0,0]
  v_pk_fma_f32 v[184:185], v[154:155], v[128:129], v[174:175] op_sel:[1,0,1] op_sel_hi:[1,1,1] neg_lo:[1,0,0] neg_hi:[1,0,0]
  v_pk_fma_f32 v[186:187], v[154:155], v[130:131], v[174:175] op_sel:[1,0,1] op_sel_hi:[1,1,1] neg_lo:[1,0,0] neg_hi:[1,0,0]
  v_pk_fma_f32 v[92:93], v[154:155], v[92:93], v[176:177] op_sel:[0,0,0] op_sel_hi:[0,1,1]
  v_pk_fma_f32 v[94:95], v[154:155], v[94:95], v[178:179] op_sel:[0,0,0] op_sel_hi:[0,1,1]
  v_pk_fma_f32 v[96:97], v[154:155], v[96:97], v[180:181] op_sel:[0,0,0] op_sel_hi:[0,1,1]
  v_pk_fma_f32 v[98:99], v[154:155], v[98:99], v[182:183] op_sel:[0,0,0] op_sel_hi:[0,1,1]
  v_pk_fma_f32 v[100:101], v[154:155], v[100:101], v[184:185] op_sel:[0,0,0] op_sel_hi:[0,1,1]
  v_pk_fma_f32 v[102:103], v[154:155], v[102:103], v[186:187] op_sel:[0,0,0] op_sel_hi:[0,1,1]
  v_pk_mul_f32 v[176:177], v[172:173], v[92:93] op_sel:[1,0] op_sel_hi:[1,1]
  v_pk_mul_f32 v[178:179], v[172:173], v[94:95] op_sel:[1,0] op_sel_hi:[1,1]
  v_pk_mul_f32 v[180:181], v[172:173], v[96:97] op_sel:[1,0] op_sel_hi:[1,1]
  v_pk_mul_f32 v[182:183], v[172:173], v[98:99] op_sel:[1,0] op_sel_hi:[1,1]
  v_pk_mul_f32 v[184:185], v[172:173], v[100:101] op_sel:[1,0] op_sel_hi:[1,1]
  v_pk_mul_f32 v[186:187], v[172:173], v[102:103] op_sel:[1,0] op_sel_hi:[1,1]
  v_exp_f32_e64 v176, v176 clamp
  v_exp_f32_e64 v177, v177 clamp
  v_exp_f32_e64 v178, v178 clamp
  v_exp_f32_e64 v179, v179 clamp
  v_exp_f32_e64 v180, v180 clamp
  v_exp_f32_e64 v181, v181 clamp
  v_exp_f32_e64 v182, v182 clamp
  v_exp_f32_e64 v183, v183 clamp
  v_exp_f32_e64 v184, v184 clamp
  v_exp_f32_e64 v185, v185 clamp
  v_exp_f32_e64 v186, v186 clamp
  v_exp_f32_e64 v187, v187 clamp
  v_max_f32 v92, v92, v175
  v_max_f32 v93, v93, v175
  v_max_f32 v94, v94, v175
  v_max_f32 v95, v95, v175
  v_max_f32 v96, v96, v175
  v_max_f32 v97, v97, v175
  v_max_f32 v98, v98, v175
  v_max_f32 v99, v99, v175
  v_max_f32 v100, v100, v175
  v_max_f32 v101, v101, v175
  v_max_f32 v102, v102, v175
  v_max_f32 v103, v103, v175
  v_pk_add_f32 v[92:93], v[92:93], v[176:177]
  v_pk_add_f32 v[94:95], v[94:95], v[178:179]
  v_pk_add_f32 v[96:97], v[96:97], v[180:181]
  v_pk_add_f32 v[98:99], v[98:99], v[182:183]
  v_pk_add_f32 v[100:101], v[100:101], v[184:185]
  v_pk_add_f32 v[102:103], v[102:103], v[186:187]
  v_cvt_pk_bf16_f32 v242, v92, v93
  v_cvt_pk_bf16_f32 v243, v94, v95
  v_cvt_pk_bf16_f32 v244, v96, v97
  v_cvt_pk_bf16_f32 v245, v98, v99
  v_cvt_pk_bf16_f32 v246, v100, v101
  v_cvt_pk_bf16_f32 v247, v102, v103
  s_mul_i32 s3, s61, 6144
  s_add_u32 s3, s3, 122880
  v_add_u32 v4, s3, v1
  v_lshl_add_u32 v5, v0, 3, s3
  ds_write_b128 v4, v[224:227] offset:0
  ds_write_b64 v5, v[228:229] offset:4096
  ds_write_b128 v4, v[230:233] offset:1024
  ds_write_b64 v5, v[234:235] offset:4608
  ds_write_b128 v4, v[236:239] offset:2048
  ds_write_b64 v5, v[240:241] offset:5120
  ds_write_b128 v4, v[242:245] offset:3072
  ds_write_b64 v5, v[246:247] offset:5632
  s_waitcnt lgkmcnt(0)
  s_lshl_b32 s3, s61, 2
  s_add_u32 s3, s3, 160272
  v_mov_b32 v4, s3
  v_mov_b32 v5, 1
  s_mov_b64 exec, 1
  ds_add_u32 v4, v5
  s_mov_b64 exec, -1
L_g2early:
  s_lshl_b32 s67, s81, 9
  s_add_u32 s67, s67, 0xd14000
  s_lshl_b32 s3, s83, 2
  s_add_u32 s67, s67, s3
  v_lshlrev_b32 v3, 2, v0
  s_mul_i32 s3, s56, 0x1111
  s_add_u32 s3, s3, 0x7610a842
  v_bfe_u32 v3, s3, v3, 4
  v_lshlrev_b32 v3, 2, v3
  s_mov_b64 exec, 0xff
  buffer_load_dword v245, v3, s[16:19], s67 offen sc1
  s_mov_b64 exec, -1
  s_lshl_b32 s3, s61, 2
  s_add_u32 s3, s3, 160288
  v_mov_b32 v246, s3
  s_mov_b32 s80, 4000000
Llw_34:
  ds_read_b32 v247, v246
  s_waitcnt lgkmcnt(0)
  v_cmp_ne_u32 vcc, 1, v247
  s_cbranch_vccz Llw_34_d
  s_sleep 1
  s_sub_u32 s80, s80, 1
  s_cbranch_scc0 Llw_34
Llw_34_d:
  s_mul_i32 s3, s61, 30720
  v_add_u32 v244, s3, v1
  ds_read_b128 v[116:119], v244 offset:0
  ds_read_b128 v[120:123], v244 offset:1024
  ds_read_b128 v[124:127], v244 offset:2048
  ds_read_b128 v[128:131], v244 offset:3072
  ds_read_b128 v[132:135], v244 offset:4096
  ds_read_b128 v[136:139], v244 offset:5120
  ds_read_b128 v[140:143], v244 offset:6144
  ds_read_b128 v[144:147], v244 offset:7168
  ds_read_b128 v[148:151], v244 offset:8192
  ds_read_b128 v[152:155], v244 offset:9216
  s_mul_i32 s3, s61, 40
  v_add_u32 v228, s3, v0
  v_mul_u32_u24 v229, 6554, v228
  v_lshrrev_b32 v229, 16, v229
  v_mul_u32_u24 v230, 10, v229
  v_sub_u32 v228, v228, v230
  v_mul_u32_u24 v230, 1280, v229
  v_lshl_add_u32 v246, v228, 4, v230
  v_lshlrev_b32 v247, 4, v228
  v_mov_b32 v230, 0x7f000000
  v_cmp_gt_u32 vcc, 40, v0
  s_mul_i32 s65, s81, 81920
  s_mul_i32 s66, s82, 160
  v_cndmask_b32 v246, v230, v246, vcc
  s_add_u32 s65, s65, s66
  v_and_b32 v229, 15, v229
  v_bfe_u32 v230, v229, 1, 2
  v_lshlrev_b32 v228, 1, v228
  v_xor_b32 v228, v228, v230
  v_mul_u32_u24 v229, 320, v229
  v_lshl_add_u32 v248, v228, 4, v229
  v_xor_b32 v249, 16, v248
  v_add_u32 v250, 61440, v248
  v_add_u32 v251, 61440, v249
  v_add_u32 v252, 122880, v248
  v_add_u32 v253, 122880, v249
  v_and_b32 v254, 15, v0
  v_lshrrev_b32 v228, 4, v0
  v_bfe_u32 v229, v0, 1, 2
  v_xor_b32 v228, v228, v229
  v_mul_u32_u24 v254, 320, v254
  v_lshl_add_u32 v254, v228, 4, v254
  s_mul_i32 s3, s61, 30720
  v_add_u32 v254, s3, v254
  s_mov_b32 s80, 200000
  s_mov_b64 exec, 0xff
L_pc:
  s_waitcnt vmcnt(0)
  v_cmp_ne_u32 vcc, s62, v245
  s_and_b32 s3, vcc_lo, 15
  s_cbranch_scc0 L_pcd
  s_sleep 2
  buffer_load_dword v245, v3, s[16:19], s67 offen sc1
  s_sub_u32 s80, s80, 1
  s_cbranch_scc0 L_pc
L_pcd:
  s_mov_b64 exec, -1
  s_mov_b32 s84, vcc_lo
  s_add_u32 s3, s44, 8192
  buffer_load_dwordx4 v[156:159], v1, s[16:19], s3 offen offset:0 sc1
  buffer_load_dwordx4 v[160:163], v1, s[16:19], s3 offen offset:1024 sc1
  buffer_load_dwordx4 v[164:167], v1, s[16:19], s3 offen offset:2048 sc1
  buffer_load_dwordx4 v[168:171], v1, s[16:19], s3 offen offset:3072 sc1
  s_add_u32 s3, s44, 16384
  buffer_load_dwordx4 v[172:175], v1, s[16:19], s3 offen offset:0 sc1
  buffer_load_dwordx4 v[176:179], v1, s[16:19], s3 offen offset:1024 sc1
  buffer_load_dwordx4 v[180:183], v1, s[16:19], s3 offen offset:2048 sc1
  buffer_load_dwordx4 v[184:187], v1, s[16:19], s3 offen offset:3072 sc1
  s_add_u32 s3, s44, 32768
  buffer_load_dwordx4 v[188:191], v1, s[16:19], s3 offen offset:0 sc1
  buffer_load_dwordx4 v[192:195], v1, s[16:19], s3 offen offset:1024 sc1
  buffer_load_dwordx4 v[196:199], v1, s[16:19], s3 offen offset:2048 sc1
  buffer_load_dwordx4 v[200:203], v1, s[16:19], s3 offen offset:3072 sc1
  s_add_u32 s3, s44, 40960
  buffer_load_dwordx4 v[204:207], v1, s[16:19], s3 offen offset:0 sc1
  buffer_load_dwordx4 v[208:211], v1, s[16:19], s3 offen offset:1024 sc1
  buffer_load_dwordx4 v[212:215], v1, s[16:19], s3 offen offset:2048 sc1
  buffer_load_dwordx4 v[224:227], v1, s[16:19], s3 offen offset:3072 sc1
  s_waitcnt vmcnt(12)
  s_waitcnt lgkmcnt(5)
  v_mfma_f32_16x16x32_bf16 v[4:7], v[116:119], v[156:159], 0
  v_mfma_f32_16x16x32_bf16 v[32:35], v[116:119], v[160:163], 0
  v_mfma_f32_16x16x32_bf16 v[60:63], v[116:119], v[164:167], 0
  v_mfma_f32_16x16x32_bf16 v[88:91], v[116:119], v[168:171], 0
  v_mfma_f32_16x16x32_bf16 v[8:11], v[120:123], v[156:159], 0
  v_mfma_f32_16x16x32_bf16 v[36:39], v[120:123], v[160:163], 0
  v_mfma_f32_16x16x32_bf16 v[64:67], v[120:123], v[164:167], 0
  v_mfma_f32_16x16x32_bf16 v[92:95], v[120:123], v[168:171], 0
  v_mfma_f32_16x16x32_bf16 v[12:15], v[124:127], v[156:159], 0
  v_mfma_f32_16x16x32_bf16 v[40:43], v[124:127], v[160:163], 0
  v_mfma_f32_16x16x32_bf16 v[68:71], v[124:127], v[164:167], 0
  v_mfma_f32_16x16x32_bf16 v[96:99], v[124:127], v[168:171], 0
  v_mfma_f32_16x16x32_bf16 v[16:19], v[128:131], v[156:159], 0
  v_mfma_f32_16x16x32_bf16 v[44:47], v[128:131], v[160:163], 0
  v_mfma_f32_16x16x32_bf16 v[72:75], v[128:131], v[164:167], 0
  v_mfma_f32_16x16x32_bf16 v[100:103], v[128:131], v[168:171], 0
  v_mfma_f32_16x16x32_bf16 v[28:31], v[132:135], v[156:159], 0
  v_mfma_f32_16x16x32_bf16 v[56:59], v[132:135], v[160:163], 0
  v_mfma_f32_16x16x32_bf16 v[84:87], v[132:135], v[164:167], 0
  v_mfma_f32_16x16x32_bf16 v[112:115], v[132:135], v[168:171], 0
  ds_read_b128 v[116:119], v244 offset:10240
  ds_read_b128 v[120:123], v244 offset:11264
  ds_read_b128 v[124:127], v244 offset:12288
  ds_read_b128 v[128:131], v244 offset:13312
  ds_read_b128 v[132:135], v244 offset:14336
  s_cmp_eq_u32 s84, 0
  s_cbranch_scc1 L_nop2
  s_mov_b32 s80, 200000
  s_mov_b64 exec, 0xff
Lpoll_he2_35:
  buffer_load_dword v245, v3, s[16:19], s67 offen sc1
  s_waitcnt vmcnt(0)
  v_cmp_ne_u32 vcc, s62, v245
  s_cbranch_vccz Lpoll_he2_35_d
  s_sleep 2
  s_sub_u32 s80, s80, 1
  s_cbranch_scc0 Lpoll_he2_35
Lpoll_he2_35_d:
  s_mov_b64 exec, -1
L_nop2:
  s_waitcnt vmcnt(8)
  s_waitcnt lgkmcnt(5)
  v_mfma_f32_16x16x32_bf16 v[4:7], v[136:139], v[172:175], v[4:7]
  v_mfma_f32_16x16x32_bf16 v[32:35], v[136:139], v[176:179], v[32:35]
  s_add_u32 s3, s36, 0
  buffer_load_dwordx4 v[228:231], v1, s[16:19], s3 offen offset:0 sc1
  v_mfma_f32_16x16x32_bf16 v[60:63], v[136:139], v[180:183], v[60:63]
  v_mfma_f32_16x16x32_bf16 v[88:91], v[136:139], v[184:187], v[88:91]
  buffer_load_dwordx4 v[232:235], v1, s[16:19], s3 offen offset:1024 sc1
  v_mfma_f32_16x16x32_bf16 v[8:11], v[140:143], v[172:175], v[8:11]
  v_mfma_f32_16x16x32_bf16 v[36:39], v[140:143], v[176:179], v[36:39]
  buffer_load_dwordx4 v[236:239], v1, s[16:19], s3 offen offset:2048 sc1
  v_mfma_f32_16x16x32_bf16 v[64:67], v[140:143], v[180:183], v[64:67]
  v_mfma_f32_16x16x32_bf16 v[92:95], v[140:143], v[184:187], v[92:95]
  buffer_load_dwordx4 v[240:243], v1, s[16:19], s3 offen offset:3072 sc1
  v_mfma_f32_16x16x32_bf16 v[12:15], v[144:147], v[172:175], v[12:15]
  v_mfma_f32_16x16x32_bf16 v[40:43], v[144:147], v[176:179], v[40:43]
  s_add_u32 s3, s36, 4096
  buffer_load_dwordx4 v[156:159], v1, s[16:19], s3 offen offset:0 sc1
  v_mfma_f32_16x16x32_bf16 v[68:71], v[144:147], v[180:183], v[68:71]
  v_mfma_f32_16x16x32_bf16 v[96:99], v[144:147], v[184:187], v[96:99]
  buffer_load_dwordx4 v[160:163], v1, s[16:19], s3 offen offset:1024 sc1
  v_mfma_f32_16x16x32_bf16 v[16:19], v[148:151], v[172:175], v[16:19]
  v_mfma_f32_16x16x32_bf16 v[44:47], v[148:151], v[176:179], v[44:47]
  buffer_load_dwordx4 v[164:167], v1, s[16:19], s3 offen offset:2048 sc1
  v_mfma_f32_16x16x32_bf16 v[72:75], v[148:151], v[180:183], v[72:75]
  v_mfma_f32_16x16x32_bf16 v[100:103], v[148:151], v[184:187], v[100:103]
  buffer_load_dwordx4 v[168:171], v1, s[16:19], s3 offen offset:3072 sc1
  v_mfma_f32_16x16x32_bf16 v[28:31], v[152:155], v[172:175], v[28:31]
  v_mfma_f32_16x16x32_bf16 v[56:59], v[152:155], v[176:179], v[56:59]
  v_mfma_f32_16x16x32_bf16 v[84:87], v[152:155], v[180:183], v[84:87]
  v_mfma_f32_16x16x32_bf16 v[112:115], v[152:155], v[184:187], v[112:115]
  ds_read_b128 v[136:139], v244 offset:15360
  ds_read_b128 v[140:143], v244 offset:16384
  ds_read_b128 v[144:147], v244 offset:17408
  ds_read_b128 v[148:151], v244 offset:18432
  ds_read_b128 v[152:155], v244 offset:19456
  s_waitcnt vmcnt(12)
  s_waitcnt lgkmcnt(5)
  v_mfma_f32_16x16x32_bf16 v[4:7], v[116:119], v[188:191], v[4:7]
  v_mfma_f32_16x16x32_bf16 v[32:35], v[116:119], v[192:195], v[32:35]
  v_mfma_f32_16x16x32_bf16 v[60:63], v[116:119], v[196:199], v[60:63]
  v_mfma_f32_16x16x32_bf16 v[88:91], v[116:119], v[200:203], v[88:91]
  s_add_u32 s3, s36, 24576
  buffer_load_dwordx4 v[172:175], v1, s[16:19], s3 offen offset:0 sc1
  v_mfma_f32_16x16x32_bf16 v[8:11], v[120:123], v[188:191], v[8:11]
  v_mfma_f32_16x16x32_bf16 v[36:39], v[120:123], v[192:195], v[36:39]
  v_mfma_f32_16x16x32_bf16 v[64:67], v[120:123], v[196:199], v[64:67]
  v_mfma_f32_16x16x32_bf16 v[92:95], v[120:123], v[200:203], v[92:95]
  buffer_load_dwordx4 v[176:179], v1, s[16:19], s3 offen offset:1024 sc1
  v_mfma_f32_16x16x32_bf16 v[12:15], v[124:127], v[188:191], v[12:15]
  v_mfma_f32_16x16x32_bf16 v[40:43], v[124:127], v[192:195], v[40:43]
  v_mfma_f32_16x16x32_bf16 v[68:71], v[124:127], v[196:199], v[68:71]
  v_mfma_f32_16x16x32_bf16 v[96:99], v[124:127], v[200:203], v[96:99]
  buffer_load_dwordx4 v[180:183], v1, s[16:19], s3 offen offset:2048 sc1
  v_mfma_f32_16x16x32_bf16 v[16:19], v[128:131], v[188:191], v[16:19]
  v_mfma_f32_16x16x32_bf16 v[44:47], v[128:131], v[192:195], v[44:47]
  v_mfma_f32_16x16x32_bf16 v[72:75], v[128:131], v[196:199], v[72:75]
  v_mfma_f32_16x16x32_bf16 v[100:103], v[128:131], v[200:203], v[100:103]
  buffer_load_dwordx4 v[184:187], v1, s[16:19], s3 offen offset:3072 sc1
  v_mfma_f32_16x16x32_bf16 v[28:31], v[132:135], v[188:191], v[28:31]
  v_mfma_f32_16x16x32_bf16 v[56:59], v[132:135], v[192:195], v[56:59]
  v_mfma_f32_16x16x32_bf16 v[84:87], v[132:135], v[196:199], v[84:87]
  v_mfma_f32_16x16x32_bf16 v[112:115], v[132:135], v[200:203], v[112:115]
  ds_read_b128 v[116:119], v244 offset:20480
  ds_read_b128 v[120:123], v244 offset:21504
  ds_read_b128 v[124:127], v244 offset:22528
  ds_read_b128 v[128:131], v244 offset:23552
  ds_read_b128 v[132:135], v244 offset:24576
  s_waitcnt vmcnt(12)
  s_waitcnt lgkmcnt(5)
  v_mfma_f32_16x16x32_bf16 v[4:7], v[136:139], v[204:207], v[4:7]
  v_mfma_f32_16x16x32_bf16 v[32:35], v[136:139], v[208:211], v[32:35]
  v_mfma_f32_16x16x32_bf16 v[60:63], v[136:139], v[212:215], v[60:63]
  v_mfma_f32_16x16x32_bf16 v[88:91], v[136:139], v[224:227], v[88:91]
  s_add_u32 s3, s36, 28672
  buffer_load_dwordx4 v[188:191], v1, s[16:19], s3 offen offset:0 sc1
  v_mfma_f32_16x16x32_bf16 v[8:11], v[140:143], v[204:207], v[8:11]
  v_mfma_f32_16x16x32_bf16 v[36:39], v[140:143], v[208:211], v[36:39]
  v_mfma_f32_16x16x32_bf16 v[64:67], v[140:143], v[212:215], v[64:67]
  v_mfma_f32_16x16x32_bf16 v[92:95], v[140:143], v[224:227], v[92:95]
  buffer_load_dwordx4 v[192:195], v1, s[16:19], s3 offen offset:1024 sc1
  v_mfma_f32_16x16x32_bf16 v[12:15], v[144:147], v[204:207], v[12:15]
  v_mfma_f32_16x16x32_bf16 v[40:43], v[144:147], v[208:211], v[40:43]
  v_mfma_f32_16x16x32_bf16 v[68:71], v[144:147], v[212:215], v[68:71]
  v_mfma_f32_16x16x32_bf16 v[96:99], v[144:147], v[224:227], v[96:99]
  buffer_load_dwordx4 v[196:199], v1, s[16:19], s3 offen offset:2048 sc1
  v_mfma_f32_16x16x32_bf16 v[16:19], v[148:151], v[204:207], v[16:19]
  v_mfma_f32_16x16x32_bf16 v[44:47], v[148:151], v[208:211], v[44:47]
  v_mfma_f32_16x16x32_bf16 v[72:75], v[148:151], v[212:215], v[72:75]
  v_mfma_f32_16x16x32_bf16 v[100:103], v[148:151], v[224:227], v[100:103]
  buffer_load_dwordx4 v[200:203], v1, s[16:19], s3 offen offset:3072 sc1
  v_mfma_f32_16x16x32_bf16 v[28:31], v[152:155], v[204:207], v[28:31]
  v_mfma_f32_16x16x32_bf16 v[56:59], v[152:155], v[208:211], v[56:59]
  v_mfma_f32_16x16x32_bf16 v[84:87], v[152:155], v[212:215], v[84:87]
  v_mfma_f32_16x16x32_bf16 v[112:115], v[152:155], v[224:227], v[112:115]
  ds_read_b128 v[136:139], v244 offset:25600
  ds_read_b128 v[140:143], v244 offset:26624
  ds_read_b128 v[144:147], v244 offset:27648
  ds_read_b128 v[148:151], v244 offset:28672
  ds_read_b128 v[152:155], v244 offset:29696
  s_waitcnt vmcnt(12)
  s_waitcnt lgkmcnt(5)
  v_mfma_f32_16x16x32_bf16 v[4:7], v[116:119], v[228:231], v[4:7]
  v_mfma_f32_16x16x32_bf16 v[32:35], v[116:119], v[232:235], v[32:35]
  v_mfma_f32_16x16x32_bf16 v[60:63], v[116:119], v[236:239], v[60:63]
  v_mfma_f32_16x16x32_bf16 v[88:91], v[116:119], v[240:243], v[88:91]
  v_mfma_f32_16x16x32_bf16 v[8:11], v[120:123], v[228:231], v[8:11]
  v_mfma_f32_16x16x32_bf16 v[36:39], v[120:123], v[232:235], v[36:39]
  v_mfma_f32_16x16x32_bf16 v[64:67], v[120:123], v[236:239], v[64:67]
  v_mfma_f32_16x16x32_bf16 v[92:95], v[120:123], v[240:243], v[92:95]
  v_mfma_f32_16x16x32_bf16 v[12:15], v[124:127], v[228:231], v[12:15]
  v_mfma_f32_16x16x32_bf16 v[40:43], v[124:127], v[232:235], v[40:43]
  v_mfma_f32_16x16x32_bf16 v[68:71], v[124:127], v[236:239], v[68:71]
  v_mfma_f32_16x16x32_bf16 v[96:99], v[124:127], v[240:243], v[96:99]
  v_mfma_f32_16x16x32_bf16 v[16:19], v[128:131], v[228:231], v[16:19]
  v_mfma_f32_16x16x32_bf16 v[44:47], v[128:131], v[232:235], v[44:47]
  v_mfma_f32_16x16x32_bf16 v[72:75], v[128:131], v[236:239], v[72:75]
  v_mfma_f32_16x16x32_bf16 v[100:103], v[128:131], v[240:243], v[100:103]
  v_mfma_f32_16x16x32_bf16 v[28:31], v[132:135], v[228:231], v[28:31]
  v_mfma_f32_16x16x32_bf16 v[56:59], v[132:135], v[232:235], v[56:59]
  v_mfma_f32_16x16x32_bf16 v[84:87], v[132:135], v[236:239], v[84:87]
  v_mfma_f32_16x16x32_bf16 v[112:115], v[132:135], v[240:243], v[112:115]
  s_waitcnt vmcnt(8)
  s_waitcnt lgkmcnt(0)
  v_mfma_f32_16x16x32_bf16 v[4:7], v[136:139], v[156:159], v[4:7]
  v_mfma_f32_16x16x32_bf16 v[32:35], v[136:139], v[160:163], v[32:35]
  v_mfma_f32_16x16x32_bf16 v[60:63], v[136:139], v[164:167], v[60:63]
  s_add_u32 s3, s65, 0
  buffer_load_dwordx4 v[116:119], v246, s[4:7], s3 offen
  v_mfma_f32_16x16x32_bf16 v[88:91], v[136:139], v[168:171], v[88:91]
  v_mfma_f32_16x16x32_bf16 v[8:11], v[140:143], v[156:159], v[8:11]
  v_mfma_f32_16x16x32_bf16 v[36:39], v[140:143], v[160:163], v[36:39]
  s_add_u32 s3, s65, 20480
  buffer_load_dwordx4 v[120:123], v246, s[4:7], s3 offen
  v_mfma_f32_16x16x32_bf16 v[64:67], v[140:143], v[164:167], v[64:67]
  v_mfma_f32_16x16x32_bf16 v[92:95], v[140:143], v[168:171], v[92:95]
  v_mfma_f32_16x16x32_bf16 v[12:15], v[144:147], v[156:159], v[12:15]
  s_add_u32 s3, s65, 40960
  buffer_load_dwordx4 v[124:127], v246, s[4:7], s3 offen
  v_mfma_f32_16x16x32_bf16 v[40:43], v[144:147], v[160:163], v[40:43]
  v_mfma_f32_16x16x32_bf16 v[68:71], v[144:147], v[164:167], v[68:71]
  v_mfma_f32_16x16x32_bf16 v[96:99], v[144:147], v[168:171], v[96:99]
  s_add_u32 s3, s65, 61440
  buffer_load_dwordx4 v[128:131], v246, s[4:7], s3 offen
  v_mfma_f32_16x16x32_bf16 v[16:19], v[148:151], v[156:159], v[16:19]
  v_mfma_f32_16x16x32_bf16 v[44:47], v[148:151], v[160:163], v[44:47]
  v_mfma_f32_16x16x32_bf16 v[72:75], v[148:151], v[164:167], v[72:75]
  buffer_load_dwordx4 v[132:135], v247, s[32:35], s66 offen
  v_mfma_f32_16x16x32_bf16 v[100:103], v[148:151], v[168:171], v[100:103]
  v_mfma_f32_16x16x32_bf16 v[28:31], v[152:155], v[156:159], v[28:31]
  v_mfma_f32_16x16x32_bf16 v[56:59], v[152:155], v[160:163], v[56:59]
  v_mfma_f32_16x16x32_bf16 v[84:87], v[152:155], v[164:167], v[84:87]
  v_mfma_f32_16x16x32_bf16 v[112:115], v[152:155], v[168:171], v[112:115]
  s_lshl_b32 s3, s61, 2
  s_add_u32 s3, s3, 160288
  v_mov_b32 v244, s3
  v_mov_b32 v245, 1
  s_mov_b64 exec, 1
  ds_add_u32 v244, v245
  s_mov_b64 exec, -1
  s_waitcnt vmcnt(5)
  v_mfma_f32_16x16x32_bf16 v[4:7], v[20:23], v[172:175], v[4:7]
  v_mfma_f32_16x16x32_bf16 v[8:11], v[24:27], v[172:175], v[8:11]
  v_mfma_f32_16x16x32_bf16 v[12:15], v[48:51], v[172:175], v[12:15]
  v_mfma_f32_16x16x32_bf16 v[16:19], v[52:55], v[172:175], v[16:19]
  v_mfma_f32_16x16x32_bf16 v[28:31], v[76:79], v[172:175], v[28:31]
  v_mfma_f32_16x16x32_bf16 v[4:7], v[80:83], v[188:191], v[4:7]
  v_mfma_f32_16x16x32_bf16 v[8:11], v[104:107], v[188:191], v[8:11]
  v_mfma_f32_16x16x32_bf16 v[12:15], v[108:111], v[188:191], v[12:15]
  v_mfma_f32_16x16x32_bf16 v[16:19], v[216:219], v[188:191], v[16:19]
  v_mfma_f32_16x16x32_bf16 v[28:31], v[220:223], v[188:191], v[28:31]
  v_mfma_f32_16x16x32_bf16 v[32:35], v[20:23], v[176:179], v[32:35]
  v_mfma_f32_16x16x32_bf16 v[36:39], v[24:27], v[176:179], v[36:39]
  v_mfma_f32_16x16x32_bf16 v[40:43], v[48:51], v[176:179], v[40:43]
  v_mfma_f32_16x16x32_bf16 v[44:47], v[52:55], v[176:179], v[44:47]
  ds_write_b128 v254, v[4:7] offset:0
  v_mfma_f32_16x16x32_bf16 v[56:59], v[76:79], v[176:179], v[56:59]
  ds_write_b128 v254, v[8:11] offset:64
  v_mfma_f32_16x16x32_bf16 v[32:35], v[80:83], v[192:195], v[32:35]
  ds_write_b128 v254, v[12:15] offset:128
  v_mfma_f32_16x16x32_bf16 v[36:39], v[104:107], v[192:195], v[36:39]
  ds_write_b128 v254, v[16:19] offset:192
  v_mfma_f32_16x16x32_bf16 v[40:43], v[108:111], v[192:195], v[40:43]
  ds_write_b128 v254, v[28:31] offset:256
  v_mfma_f32_16x16x32_bf16 v[44:47], v[216:219], v[192:195], v[44:47]
  v_mfma_f32_16x16x32_bf16 v[56:59], v[220:223], v[192:195], v[56:59]
  v_mfma_f32_16x16x32_bf16 v[60:63], v[20:23], v[180:183], v[60:63]
  v_mfma_f32_16x16x32_bf16 v[64:67], v[24:27], v[180:183], v[64:67]
  v_mfma_f32_16x16x32_bf16 v[68:71], v[48:51], v[180:183], v[68:71]
  v_mfma_f32_16x16x32_bf16 v[72:75], v[52:55], v[180:183], v[72:75]
  ds_write_b128 v254, v[32:35] offset:5120
  v_mfma_f32_16x16x32_bf16 v[84:87], v[76:79], v[180:183], v[84:87]
  ds_write_b128 v254, v[36:39] offset:5184
  v_mfma_f32_16x16x32_bf16 v[60:63], v[80:83], v[196:199], v[60:63]
  ds_write_b128 v254, v[40:43] offset:5248
  v_mfma_f32_16x16x32_bf16 v[64:67], v[104:107], v[196:199], v[64:67]
  ds_write_b128 v254, v[44:47] offset:5312
  v_mfma_f32_16x16x32_bf16 v[68:71], v[108:111], v[196:199], v[68:71]
  ds_write_b128 v254, v[56:59] offset:5376
  v_mfma_f32_16x16x32_bf16 v[72:75], v[216:219], v[196:199], v[72:75]
  v_mfma_f32_16x16x32_bf16 v[84:87], v[220:223], v[196:199], v[84:87]
  v_mfma_f32_16x16x32_bf16 v[88:91], v[20:23], v[184:187], v[88:91]
  v_mfma_f32_16x16x32_bf16 v[92:95], v[24:27], v[184:187], v[92:95]
  v_mfma_f32_16x16x32_bf16 v[96:99], v[48:51], v[184:187], v[96:99]
  v_mfma_f32_16x16x32_bf16 v[100:103], v[52:55], v[184:187], v[100:103]
  ds_write_b128 v254, v[60:63] offset:10240
  v_mfma_f32_16x16x32_bf16 v[112:115], v[76:79], v[184:187], v[112:115]
  ds_write_b128 v254, v[64:67] offset:10304
  v_mfma_f32_16x16x32_bf16 v[88:91], v[80:83], v[200:203], v[88:91]
  ds_write_b128 v254, v[68:71] offset:10368
  v_mfma_f32_16x16x32_bf16 v[92:95], v[104:107], v[200:203], v[92:95]
  ds_write_b128 v254, v[72:75] offset:10432
  v_mfma_f32_16x16x32_bf16 v[96:99], v[108:111], v[200:203], v[96:99]
  ds_write_b128 v254, v[84:87] offset:10496
  v_mfma_f32_16x16x32_bf16 v[100:103], v[216:219], v[200:203], v[100:103]
  v_mfma_f32_16x16x32_bf16 v[112:115], v[220:223], v[200:203], v[112:115]
  s_waitcnt vmcnt(0)
  v_lshlrev_b32 v136, 16, v132
  v_and_b32 v137, 0xffff0000, v132
  v_lshlrev_b32 v138, 16, v133
  v_and_b32 v139, 0xffff0000, v133
  ds_write_b128 v254, v[88:91] offset:15360
  ds_write_b128 v254, v[92:95] offset:15424
  ds_write_b128 v254, v[96:99] offset:15488
  ds_write_b128 v254, v[100:103] offset:15552
  ds_write_b128 v254, v[112:115] offset:15616
  v_lshlrev_b32 v140, 16, v134
  v_and_b32 v141, 0xffff0000, v134
  v_lshlrev_b32 v142, 16, v135
  v_and_b32 v143, 0xffff0000, v135
  v_mov_b32 v244, 160264
  v_mov_b32 v245, 1
  v_lshlrev_b32 v204, 16, v116
  v_and_b32 v205, 0xffff0000, v116
  v_lshlrev_b32 v206, 16, v117
  v_and_b32 v207, 0xffff0000, v117
  v_lshlrev_b32 v208, 16, v118
  v_and_b32 v209, 0xffff0000, v118
  v_lshlrev_b32 v210, 16, v119
  v_and_b32 v211, 0xffff0000, v119
  s_mov_b64 exec, 1
  s_waitcnt lgkmcnt(0)
  ds_add_u32 v244, v245
  s_mov_b64 exec, -1
  v_add_f32 v204, v204, v136
  v_add_f32 v205, v205, v137
  v_add_f32 v206, v206, v138
  v_add_f32 v207, v207, v139
  v_add_f32 v208, v208, v140
  v_add_f32 v209, v209, v141
  v_add_f32 v210, v210, v142
  v_add_f32 v211, v211, v143
  v_lshlrev_b32 v212, 16, v120
  v_and_b32 v213, 0xffff0000, v120
  v_lshlrev_b32 v214, 16, v121
  v_and_b32 v215, 0xffff0000, v121
  v_lshlrev_b32 v224, 16, v122
  v_and_b32 v225, 0xffff0000, v122
  v_lshlrev_b32 v226, 16, v123
  v_and_b32 v227, 0xffff0000, v123
  v_add_f32 v212, v212, v136
  v_add_f32 v213, v213, v137
  v_add_f32 v214, v214, v138
  v_add_f32 v215, v215, v139
  v_add_f32 v224, v224, v140
  v_add_f32 v225, v225, v141
  v_add_f32 v226, v226, v142
  v_add_f32 v227, v227, v143
  v_lshlrev_b32 v228, 16, v124
  v_and_b32 v229, 0xffff0000, v124
  v_lshlrev_b32 v230, 16, v125
  v_and_b32 v231, 0xffff0000, v125
  v_lshlrev_b32 v232, 16, v126
  v_and_b32 v233, 0xffff0000, v126
  v_lshlrev_b32 v234, 16, v127
  v_and_b32 v235, 0xffff0000, v127
  v_add_f32 v228, v228, v136
  v_add_f32 v229, v229, v137
  v_add_f32 v230, v230, v138
  v_add_f32 v231, v231, v139
  v_add_f32 v232, v232, v140
  v_add_f32 v233, v233, v141
  v_add_f32 v234, v234, v142
  v_add_f32 v235, v235, v143
  v_lshlrev_b32 v236, 16, v128
  v_and_b32 v237, 0xffff0000, v128
  v_lshlrev_b32 v238, 16, v129
  v_and_b32 v239, 0xffff0000, v129
  v_lshlrev_b32 v240, 16, v130
  v_and_b32 v241, 0xffff0000, v130
  v_lshlrev_b32 v242, 16, v131
  v_and_b32 v243, 0xffff0000, v131
  v_add_f32 v236, v236, v136
  v_add_f32 v237, v237, v137
  v_add_f32 v238, v238, v138
  v_add_f32 v239, v239, v139
  v_add_f32 v240, v240, v140
  v_add_f32 v241, v241, v141
  v_add_f32 v242, v242, v142
  v_add_f32 v243, v243, v143
  v_mov_b32 v244, 160264
  s_mov_b32 s80, 4000000
Llg_36:
  ds_read_b32 v245, v244
  s_waitcnt lgkmcnt(0)
  v_cmp_gt_u32 vcc, 4, v245
  s_cbranch_vccz Llg_36_d
  s_sleep 1
  s_sub_u32 s80, s80, 1
  s_cbranch_scc0 Llg_36
Llg_36_d:
  s_mov_b32 exec_hi, 0xff
  ds_read_b128 v[4:7], v248 offset:0
  ds_read_b128 v[8:11], v249 offset:0
  ds_read_b128 v[12:15], v248 offset:30720
  ds_read_b128 v[16:19], v249 offset:30720
  ds_read_b128 v[20:23], v250 offset:0
  ds_read_b128 v[24:27], v251 offset:0
  ds_read_b128 v[28:31], v250 offset:30720
  ds_read_b128 v[32:35], v251 offset:30720
  ds_read_b128 v[36:39], v248 offset:5120
  ds_read_b128 v[40:43], v249 offset:5120
  ds_read_b128 v[44:47], v248 offset:35840
  ds_read_b128 v[48:51], v249 offset:35840
  ds_read_b128 v[52:55], v250 offset:5120
  ds_read_b128 v[56:59], v251 offset:5120
  ds_read_b128 v[60:63], v250 offset:35840
  ds_read_b128 v[64:67], v251 offset:35840
  s_waitcnt lgkmcnt(14)
  v_add_f32 v204, v204, v4
  v_add_f32 v205, v205, v5
  v_add_f32 v206, v206, v6
  v_add_f32 v207, v207, v7
  v_add_f32 v208, v208, v8
  v_add_f32 v209, v209, v9
  v_add_f32 v210, v210, v10
  v_add_f32 v211, v211, v11
  s_waitcnt lgkmcnt(12)
  v_add_f32 v204, v204, v12
  v_add_f32 v205, v205, v13
  v_add_f32 v206, v206, v14
  v_add_f32 v207, v207, v15
  v_add_f32 v208, v208, v16
  v_add_f32 v209, v209, v17
  v_add_f32 v210, v210, v18
  v_add_f32 v211, v211, v19
  s_waitcnt lgkmcnt(10)
  v_add_f32 v204, v204, v20
  v_add_f32 v205, v205, v21
  v_add_f32 v206, v206, v22
  v_add_f32 v207, v207, v23
  v_add_f32 v208, v208, v24
  v_add_f32 v209, v209, v25
  v_add_f32 v210, v210, v26
  v_add_f32 v211, v211, v27
  s_waitcnt lgkmcnt(8)
  v_add_f32 v204, v204, v28
  v_add_f32 v205, v205, v29
  v_add_f32 v206, v206, v30
  v_add_f32 v207, v207, v31
  v_add_f32 v208, v208, v32
  v_add_f32 v209, v209, v33
  v_add_f32 v210, v210, v34
  v_add_f32 v211, v211, v35
  ds_read_b128 v[4:7], v248 offset:10240
  ds_read_b128 v[8:11], v249 offset:10240
  ds_read_b128 v[12:15], v248 offset:40960
  ds_read_b128 v[16:19], v249 offset:40960
  ds_read_b128 v[20:23], v250 offset:10240
  ds_read_b128 v[24:27], v251 offset:10240
  ds_read_b128 v[28:31], v250 offset:40960
  ds_read_b128 v[32:35], v251 offset:40960
  s_waitcnt lgkmcnt(14)
  v_add_f32 v212, v212, v36
  v_add_f32 v213, v213, v37
  v_add_f32 v214, v214, v38
  v_add_f32 v215, v215, v39
  v_add_f32 v224, v224, v40
  v_add_f32 v225, v225, v41
  v_add_f32 v226, v226, v42
  v_add_f32 v227, v227, v43
  s_waitcnt lgkmcnt(12)
  v_add_f32 v212, v212, v44
  v_add_f32 v213, v213, v45
  v_add_f32 v214, v214, v46
  v_add_f32 v215, v215, v47
  v_add_f32 v224, v224, v48
  v_add_f32 v225, v225, v49
  v_add_f32 v226, v226, v50
  v_add_f32 v227, v227, v51
  s_waitcnt lgkmcnt(10)
  v_add_f32 v212, v212, v52
  v_add_f32 v213, v213, v53
  v_add_f32 v214, v214, v54
  v_add_f32 v215, v215, v55
  v_add_f32 v224, v224, v56
  v_add_f32 v225, v225, v57
  v_add_f32 v226, v226, v58
  v_add_f32 v227, v227, v59
  s_waitcnt lgkmcnt(8)
  v_add_f32 v212, v212, v60
  v_add_f32 v213, v213, v61
  v_add_f32 v214, v214, v62
  v_add_f32 v215, v215, v63
  v_add_f32 v224, v224, v64
  v_add_f32 v225, v225, v65
  v_add_f32 v226, v226, v66
  v_add_f32 v227, v227, v67
  ds_read_b128 v[36:39], v248 offset:15360
  ds_read_b128 v[40:43], v249 offset:15360
  ds_read_b128 v[44:47], v248 offset:46080
  ds_read_b128 v[48:51], v249 offset:46080
  ds_read_b128 v[52:55], v250 offset:15360
  ds_read_b128 v[56:59], v251 offset:15360
  ds_read_b128 v[60:63], v250 offset:46080
  ds_read_b128 v[64:67], v251 offset:46080
  s_waitcnt lgkmcnt(14)
  v_add_f32 v228, v228, v4
  v_add_f32 v229, v229, v5
  v_add_f32 v230, v230, v6
  v_add_f32 v231, v231, v7
  v_add_f32 v232, v232, v8
  v_add_f32 v233, v233, v9
  v_add_f32 v234, v234, v10
  v_add_f32 v235, v235, v11
  s_waitcnt lgkmcnt(12)
  v_add_f32 v228, v228, v12
  v_add_f32 v229, v229, v13
  v_add_f32 v230, v230, v14
  v_add_f32 v231, v231, v15
  v_add_f32 v232, v232, v16
  v_add_f32 v233, v233, v17
  v_add_f32 v234, v234, v18
  v_add_f32 v235, v235, v19
  s_waitcnt lgkmcnt(10)
  v_add_f32 v228, v228, v20
  v_add_f32 v229, v229, v21
  v_add_f32 v230, v230, v22
  v_add_f32 v231, v231, v23
  v_add_f32 v232, v232, v24
  v_add_f32 v233, v233, v25
  v_add_f32 v234, v234, v26
  v_add_f32 v235, v235, v27
  s_waitcnt lgkmcnt(8)
  v_add_f32 v228, v228, v28
  v_add_f32 v229, v229, v29
  v_add_f32 v230, v230, v30
  v_add_f32 v231, v231, v31
  v_add_f32 v232, v232, v32
  v_add_f32 v233, v233, v33
  v_add_f32 v234, v234, v34
  v_add_f32 v235, v235, v35
  s_waitcnt lgkmcnt(6)
  v_add_f32 v236, v236, v36
  v_add_f32 v237, v237, v37
  v_add_f32 v238, v238, v38
  v_add_f32 v239, v239, v39
  v_add_f32 v240, v240, v40
  v_add_f32 v241, v241, v41
  v_add_f32 v242, v242, v42
  v_add_f32 v243, v243, v43
  s_waitcnt lgkmcnt(4)
  v_add_f32 v236, v236, v44
  v_add_f32 v237, v237, v45
  v_add_f32 v238, v238, v46
  v_add_f32 v239, v239, v47
  v_add_f32 v240, v240, v48
  v_add_f32 v241, v241, v49
  v_add_f32 v242, v242, v50
  v_add_f32 v243, v243, v51
  s_waitcnt lgkmcnt(2)
  v_add_f32 v236, v236, v52
  v_add_f32 v237, v237, v53
  v_add_f32 v238, v238, v54
  v_add_f32 v239, v239, v55
  v_add_f32 v240, v240, v56
  v_add_f32 v241, v241, v57
  v_add_f32 v242, v242, v58
  v_add_f32 v243, v243, v59
  s_waitcnt lgkmcnt(0)
  v_add_f32 v236, v236, v60
  v_add_f32 v237, v237, v61
  v_add_f32 v238, v238, v62
  v_add_f32 v239, v239, v63
  v_add_f32 v240, v240, v64
  v_add_f32 v241, v241, v65
  v_add_f32 v242, v242, v66
  v_add_f32 v243, v243, v67
  v_mov_b32 v245, 1
  s_mov_b64 exec, 1
  ds_add_u32 v244, v245
  s_mov_b32 exec_lo, -1
  s_mov_b32 exec_hi, 0xff
  s_setprio 1
  v_mov_b32 v244, 160304
  s_mov_b32 s80, 4000000
Llw_37:
  ds_read_b32 v245, v244
  s_waitcnt lgkmcnt(0)
  v_cmp_ne_u32 vcc, 4, v245
  s_cbranch_vccz Llw_37_d
  s_sleep 1
  s_sub_u32 s80, s80, 1
  s_cbranch_scc0 Llw_37
Llw_37_d:
  ds_read_b128 v[4:7], v248 offset:20480
  ds_read_b128 v[8:11], v249 offset:20480
  ds_read_b128 v[12:15], v248 offset:51200
  ds_read_b128 v[16:19], v249 offset:51200
  ds_read_b128 v[20:23], v250 offset:20480
  ds_read_b128 v[24:27], v251 offset:20480
  ds_read_b128 v[28:31], v250 offset:51200
  ds_read_b128 v[32:35], v251 offset:51200
  s_add_u32 s3, s65, 0
  s_waitcnt lgkmcnt(6)
  v_add_f32 v204, v204, v4
  v_add_f32 v205, v205, v5
  v_add_f32 v206, v206, v6
  v_add_f32 v207, v207, v7
  v_add_f32 v208, v208, v8
  v_add_f32 v209, v209, v9
  v_add_f32 v210, v210, v10
  v_add_f32 v211, v211, v11
  s_waitcnt lgkmcnt(4)
  v_add_f32 v204, v204, v12
  v_add_f32 v205, v205, v13
  v_add_f32 v206, v206, v14
  v_add_f32 v207, v207, v15
  v_add_f32 v208, v208, v16
  v_add_f32 v209, v209, v17
  v_add_f32 v210, v210, v18
  v_add_f32 v211, v211, v19
  s_waitcnt lgkmcnt(2)
  v_add_f32 v204, v204, v20
  v_add_f32 v205, v205, v21
  v_add_f32 v206, v206, v22
  v_add_f32 v207, v207, v23
  v_add_f32 v208, v208, v24
  v_add_f32 v209, v209, v25
  v_add_f32 v210, v210, v26
  v_add_f32 v211, v211, v27
  s_waitcnt lgkmcnt(0)
  v_add_f32 v204, v204, v28
  v_add_f32 v205, v205, v29
  v_add_f32 v206, v206, v30
  v_add_f32 v207, v207, v31
  v_add_f32 v208, v208, v32
  v_add_f32 v209, v209, v33
  v_add_f32 v210, v210, v34
  v_add_f32 v211, v211, v35
  v_cvt_pk_bf16_f32 v204, v204, v205
  v_cvt_pk_bf16_f32 v205, v206, v207
  v_cvt_pk_bf16_f32 v206, v208, v209
  v_cvt_pk_bf16_f32 v207, v210, v211
  buffer_store_dwordx4 v[204:207], v246, s[24:27], s3 offen
  v_mov_b32 v244, 160308
  s_mov_b32 s80, 4000000
Llw_38:
  ds_read_b32 v245, v244
  s_waitcnt lgkmcnt(0)
  v_cmp_ne_u32 vcc, 4, v245
  s_cbranch_vccz Llw_38_d
  s_sleep 1
  s_sub_u32 s80, s80, 1
  s_cbranch_scc0 Llw_38
Llw_38_d:
  ds_read_b128 v[36:39], v248 offset:25600
  ds_read_b128 v[40:43], v249 offset:25600
  ds_read_b128 v[44:47], v248 offset:56320
  ds_read_b128 v[48:51], v249 offset:56320
  ds_read_b128 v[52:55], v250 offset:25600
  ds_read_b128 v[56:59], v251 offset:25600
  ds_read_b128 v[60:63], v250 offset:56320
  ds_read_b128 v[64:67], v251 offset:56320
  s_add_u32 s3, s65, 20480
  s_waitcnt lgkmcnt(6)
  v_add_f32 v212, v212, v36
  v_add_f32 v213, v213, v37
  v_add_f32 v214, v214, v38
  v_add_f32 v215, v215, v39
  v_add_f32 v224, v224, v40
  v_add_f32 v225, v225, v41
  v_add_f32 v226, v226, v42
  v_add_f32 v227, v227, v43
  s_waitcnt lgkmcnt(4)
  v_add_f32 v212, v212, v44
  v_add_f32 v213, v213, v45
  v_add_f32 v214, v214, v46
  v_add_f32 v215, v215, v47
  v_add_f32 v224, v224, v48
  v_add_f32 v225, v225, v49
  v_add_f32 v226, v226, v50
  v_add_f32 v227, v227, v51
  s_waitcnt lgkmcnt(2)
  v_add_f32 v212, v212, v52
  v_add_f32 v213, v213, v53
  v_add_f32 v214, v214, v54
  v_add_f32 v215, v215, v55
  v_add_f32 v224, v224, v56
  v_add_f32 v225, v225, v57
  v_add_f32 v226, v226, v58
  v_add_f32 v227, v227, v59
  s_waitcnt lgkmcnt(0)
  v_add_f32 v212, v212, v60
  v_add_f32 v213, v213, v61
  v_add_f32 v214, v214, v62
  v_add_f32 v215, v215, v63
  v_add_f32 v224, v224, v64
  v_add_f32 v225, v225, v65
  v_add_f32 v226, v226, v66
  v_add_f32 v227, v227, v67
  v_cvt_pk_bf16_f32 v212, v212, v213
  v_cvt_pk_bf16_f32 v213, v214, v215
  v_cvt_pk_bf16_f32 v214, v224, v225
  v_cvt_pk_bf16_f32 v215, v226, v227
  buffer_store_dwordx4 v[212:215], v246, s[24:27], s3 offen
  v_mov_b32 v244, 160312
  s_mov_b32 s80, 4000000
Llw_39:
  ds_read_b32 v245, v244
  s_waitcnt lgkmcnt(0)
  v_cmp_ne_u32 vcc, 4, v245
  s_cbranch_vccz Llw_39_d
  s_sleep 1
  s_sub_u32 s80, s80, 1
  s_cbranch_scc0 Llw_39
Llw_39_d:
  ds_read_b128 v[4:7], v252 offset:0
  ds_read_b128 v[8:11], v253 offset:0
  ds_read_b128 v[12:15], v252 offset:5120
  ds_read_b128 v[16:19], v253 offset:5120
  ds_read_b128 v[20:23], v252 offset:10240
  ds_read_b128 v[24:27], v253 offset:10240
  ds_read_b128 v[28:31], v252 offset:15360
  ds_read_b128 v[32:35], v253 offset:15360
  s_add_u32 s3, s65, 40960
  s_waitcnt lgkmcnt(6)
  v_add_f32 v228, v228, v4
  v_add_f32 v229, v229, v5
  v_add_f32 v230, v230, v6
  v_add_f32 v231, v231, v7
  v_add_f32 v232, v232, v8
  v_add_f32 v233, v233, v9
  v_add_f32 v234, v234, v10
  v_add_f32 v235, v235, v11
  s_waitcnt lgkmcnt(4)
  v_add_f32 v228, v228, v12
  v_add_f32 v229, v229, v13
  v_add_f32 v230, v230, v14
  v_add_f32 v231, v231, v15
  v_add_f32 v232, v232, v16
  v_add_f32 v233, v233, v17
  v_add_f32 v234, v234, v18
  v_add_f32 v235, v235, v19
  s_waitcnt lgkmcnt(2)
  v_add_f32 v228, v228, v20
  v_add_f32 v229, v229, v21
  v_add_f32 v230, v230, v22
  v_add_f32 v231, v231, v23
  v_add_f32 v232, v232, v24
  v_add_f32 v233, v233, v25
  v_add_f32 v234, v234, v26
  v_add_f32 v235, v235, v27
  s_waitcnt lgkmcnt(0)
  v_add_f32 v228, v228, v28
  v_add_f32 v229, v229, v29
  v_add_f32 v230, v230, v30
  v_add_f32 v231, v231, v31
  v_add_f32 v232, v232, v32
  v_add_f32 v233, v233, v33
  v_add_f32 v234, v234, v34
  v_add_f32 v235, v235, v35
  v_cvt_pk_bf16_f32 v228, v228, v229
  v_cvt_pk_bf16_f32 v229, v230, v231
  v_cvt_pk_bf16_f32 v230, v232, v233
  v_cvt_pk_bf16_f32 v231, v234, v235
  buffer_store_dwordx4 v[228:231], v246, s[24:27], s3 offen
  v_mov_b32 v244, 160316
  s_mov_b32 s80, 4000000
Llw_40:
  ds_read_b32 v245, v244
  s_waitcnt lgkmcnt(0)
  v_cmp_ne_u32 vcc, 4, v245
  s_cbranch_vccz Llw_40_d
  s_sub_u32 s80, s80, 1
  s_cbranch_scc0 Llw_40
Llw_40_d:
  ds_read_b128 v[36:39], v248 offset:0
  ds_read_b128 v[40:43], v249 offset:0
  ds_read_b128 v[44:47], v248 offset:30720
  ds_read_b128 v[48:51], v249 offset:30720
  ds_read_b128 v[52:55], v250 offset:0
  ds_read_b128 v[56:59], v251 offset:0
  ds_read_b128 v[60:63], v250 offset:30720
  ds_read_b128 v[64:67], v251 offset:30720
  s_add_u32 s3, s65, 61440
  s_waitcnt lgkmcnt(6)
  v_pk_add_f32 v[236:237], v[236:237], v[36:37]
  v_pk_add_f32 v[238:239], v[238:239], v[38:39]
  v_pk_add_f32 v[240:241], v[240:241], v[40:41]
  v_pk_add_f32 v[242:243], v[242:243], v[42:43]
  s_waitcnt lgkmcnt(4)
  v_pk_add_f32 v[236:237], v[236:237], v[44:45]
  v_pk_add_f32 v[238:239], v[238:239], v[46:47]
  v_pk_add_f32 v[240:241], v[240:241], v[48:49]
  v_pk_add_f32 v[242:243], v[242:243], v[50:51]
  s_waitcnt lgkmcnt(2)
  v_pk_add_f32 v[236:237], v[236:237], v[52:53]
  v_pk_add_f32 v[238:239], v[238:239], v[54:55]
  v_pk_add_f32 v[240:241], v[240:241], v[56:57]
  v_pk_add_f32 v[242:243], v[242:243], v[58:59]
  s_waitcnt lgkmcnt(0)
  v_pk_add_f32 v[236:237], v[236:237], v[60:61]
  v_pk_add_f32 v[238:239], v[238:239], v[62:63]
  v_pk_add_f32 v[240:241], v[240:241], v[64:65]
  v_pk_add_f32 v[242:243], v[242:243], v[66:67]
  v_cvt_pk_bf16_f32 v236, v236, v237
  v_cvt_pk_bf16_f32 v237, v238, v239
  v_cvt_pk_bf16_f32 v238, v240, v241
  v_cvt_pk_bf16_f32 v239, v242, v243
  buffer_store_dwordx4 v[236:239], v246, s[24:27], s3 offen
  s_mov_b64 exec, -1
L_alldone:
  s_cmp_lg_u32 s2, 0
  s_cbranch_scc1 L_end
  s_cmp_lg_u32 s61, 4
  s_cbranch_scc1 L_end
  s_mov_b32 s3, 0xd10000
  v_mov_b32 v2, s62
  v_mov_b32 v3, 0
  s_mov_b64 exec, 1
  buffer_store_dword v2, v3, s[16:19], s3 offen sc1
L_end:
  s_endpgm
Lsl_8:
  buffer_store_dwordx4 v[224:227], v1, s[16:19], s66 offen offset:0 sc1
  s_branch Lsl_8_b
Lsl_9:
  buffer_store_dwordx4 v[230:233], v1, s[16:19], s66 offen offset:1024 sc1
  s_branch Lsl_9_b
Lsl_10:
  buffer_store_dwordx4 v[236:239], v1, s[16:19], s66 offen offset:2048 sc1
  s_branch Lsl_10_b
Lsl_11:
  buffer_store_dwordx4 v[242:245], v1, s[16:19], s66 offen offset:3072 sc1
  s_branch Lsl_11_b
Lsl_12:
  buffer_store_dwordx4 v[156:159], v252, s[16:19], s67 offen sc1
  s_branch Lsl_12_b
Lsl_13:
  buffer_store_dword v254, v255, s[16:19], s3 offen sc1
  s_branch Lsl_13_b
Lsl_19:
  buffer_store_dwordx4 v[28:31], v1, s[16:19], s66 offen offset:0 sc1
  s_branch Lsl_19_b
Lsl_20:
  buffer_store_dwordx4 v[56:59], v1, s[16:19], s66 offen offset:1024 sc1
  s_branch Lsl_20_b
Lsl_21:
  buffer_store_dwordx4 v[84:87], v1, s[16:19], s66 offen offset:2048 sc1
  s_branch Lsl_21_b
Lsl_22:
  buffer_store_dwordx4 v[112:115], v1, s[16:19], s66 offen offset:3072 sc1
  s_branch Lsl_22_b
Lsl_23:
  buffer_store_dword v6, v7, s[16:19], s3 offen sc1
  s_branch Lsl_23_b
Lsl_24:
  buffer_store_dwordx4 v[20:23], v1, s[16:19], s66 offen offset:0 sc1
  s_branch Lsl_24_b
Lsl_25:
  buffer_store_dwordx4 v[48:51], v1, s[16:19], s66 offen offset:1024 sc1
  s_branch Lsl_25_b
Lsl_26:
  buffer_store_dwordx4 v[76:79], v1, s[16:19], s66 offen offset:2048 sc1
  s_branch Lsl_26_b
Lsl_27:
  buffer_store_dwordx4 v[104:107], v1, s[16:19], s66 offen offset:3072 sc1
  s_branch Lsl_27_b
Lsl_28:
  buffer_store_dwordx4 v[28:31], v1, s[16:19], s67 offen offset:0 sc1
  s_branch Lsl_28_b
Lsl_29:
  buffer_store_dword v4, v5, s[16:19], s3 offen sc1
  s_branch Lsl_29_b
Lsl_30:
  buffer_store_dwordx4 v[56:59], v1, s[16:19], s67 offen offset:1024 sc1
  s_branch Lsl_30_b
Lsl_31:
  buffer_store_dwordx4 v[84:87], v1, s[16:19], s67 offen offset:2048 sc1
  s_branch Lsl_31_b
Lsl_32:
  buffer_store_dwordx4 v[112:115], v1, s[16:19], s67 offen offset:3072 sc1
  s_branch Lsl_32_b
Lsl_33:
  buffer_store_dword v4, v5, s[16:19], s3 offen sc1
  s_branch Lsl_33_b
.p2align 7
.type L_table,@object
L_table:
  .long 123008, 132368, 123264, 132624, 123520, 132880, 123776, 134160
  .long 125056, 132128, 123024, 132384, 123280, 132640, 123536, 132896
  .long 123792, 134176, 125072, 132144, 123040, 132400, 123296, 132656
  .long 123552, 132912, 123808, 134192, 125088, 132160, 123056, 132416
  .long 123312, 132672, 123568, 132928, 123824, 134208, 125104, 132176
  .long 123072, 132432, 123328, 132688, 123584, 132944, 123840, 134224
  .long 125120, 132192, 123088, 132448, 123344, 132704, 123600, 132960
  .long 123856, 134240, 125136, 132208, 123104, 132464, 123360, 132720
  .long 123616, 132976, 123872, 134256, 125152, 132224, 123120, 132480
  .long 123376, 132736, 123632, 132992, 123888, 134272, 125168, 132240
  .long 123904, 132496, 124160, 132752, 124416, 133008, 124672, 134288
  .long 125952, 132256, 123920, 132512, 124176, 132768, 124432, 133024
  .long 124688, 134304, 125968, 132272, 123936, 132528, 124192, 132784
  .long 124448, 133040, 124704, 134320, 125984, 131072, 123952, 131328
  .long 124208, 131584, 124464, 131840, 124720, 133120, 126000, 134592
  .long 123968, 134848, 124224, 135104, 124480, 137408, 124736, 137664
  .long 126016, 134608, 123984, 134864, 124240, 135120, 124496, 137424
  .long 124752, 137680, 126032, 134624, 124000, 134880, 124256, 135136
  .long 124512, 137440, 124768, 137696, 126048, 134640, 124016, 134896
  .long 124272, 135152, 124528, 137456, 124784, 137712, 126064, 135424
  .long 124032, 135680, 124288, 135936, 124544, 138240, 124800, 138496
  .long 126080, 135440, 124048, 135696, 124304, 135952, 124560, 138256
  .long 124816, 138512, 126096, 135456, 124064, 135712, 124320, 135968
  .long 124576, 138272, 124832, 138528, 126112, 135472, 124080, 135728
  .long 124336, 135984, 124592, 138288, 124848, 138544, 126128, 135488
  .long 122880, 135744, 123136, 136000, 123392, 138304, 123648, 138560
  .long 124928, 135504, 126400, 135760, 126656, 136016, 126912, 138320
  .long 129216, 138576, 129472, 135520, 126416, 135776, 126672, 136032
  .long 126928, 138336, 129232, 138592, 129488, 135536, 126432, 135792
  .long 126688, 136048, 126944, 138352, 129248, 138608, 129504, 135552
  .long 126448, 135808, 126704, 136064, 126960, 138368, 129264, 138624
  .long 129520, 135568, 127232, 135824, 127488, 136080, 127744, 138384
  .long 130048, 138640, 130304, 135584, 127248, 135840, 127504, 136096
  .long 127760, 138400, 130064, 138656, 130320, 135600, 127264, 135856
  .long 127520, 136112, 127776, 138416, 130080, 138672, 130336, 135616
  .long 127280, 135872, 127536, 136128, 127792, 138432, 130096, 138688
  .long 130352, 135632, 127296, 135888, 127552, 136144, 127808, 138448
  .long 130112, 138704, 130368, 135648, 127312, 135904, 127568, 136160
  .long 127824, 138464, 130128, 138720, 130384, 135664, 127328, 135920
  .long 127584, 136176, 127840, 138480, 130144, 138736, 130400, 133376
  .long 127344, 133632, 127600, 133888, 127856, 136192, 130160, 136448
  .long 130416, 130416, 127360, 127360, 127616, 127616, 127872, 127872
  .long 130176, 130176, 130432, 130432, 127376, 127376, 127632, 127632
  .long 127888, 127888, 130192, 130192, 130448, 130448, 127392, 127392
  .long 127648, 127648, 127904, 127904, 130208, 130208, 130464, 130464
  .long 127408, 127408, 127664, 127664, 127920, 127920, 130224, 130224
  .long 130480, 130480, 127424, 127424, 127680, 127680, 127936, 127936
  .long 130240, 130240, 130496, 130496, 127440, 127440, 127696, 127696
  .long 127952, 127952, 130256, 130256, 130512, 130512, 127456, 127456
  .long 127712, 127712, 127968, 127968, 130272, 130272, 130528, 130528
  .long 127472, 127472, 127728, 127728, 127984, 127984, 130288, 130288
  .long 130544, 130544, 125184, 125184, 125440, 125440, 125696, 125696
  .long 128000, 128000, 128256, 128256, 131200, 131200, 131456, 131456
  .long 131712, 131712, 131968, 131968, 133248, 133248, 131216, 131216
  .long 131472, 131472, 131728, 131728, 131984, 131984, 133264, 133264
  .long 131232, 131232, 131488, 131488, 131744, 131744, 132000, 132000
  .long 133280, 133280, 131248, 131248, 131504, 131504, 131760, 131760
  .long 132016, 132016, 133296, 133296, 131264, 131264, 131520, 131520
  .long 131776, 131776, 132032, 132032, 133312, 133312, 131280, 131280
  .long 131536, 131536, 131792, 131792, 132048, 132048, 133328, 133328
  .long 131296, 131296, 131552, 131552, 131808, 131808, 132064, 132064
  .long 133344, 133344, 131312, 131312, 131568, 131568, 131824, 131824
  .long 132080, 132080, 133360, 133360, 132096, 132096, 132352, 132352
  .long 132608, 132608, 132864, 132864, 134144, 134144, 132112, 132112
  .long 147456, 152656, 147472, 152672, 147488, 152688, 147504, 152648
  .long 147464, 152704, 147520, 152720, 147536, 152736, 147552, 152752
  .long 147568, 152712, 147528, 152768, 147584, 152784, 147600, 152800
  .long 147616, 152816, 147632, 152776, 147592, 152832, 147648, 152848
  .long 147664, 152864, 147680, 152880, 147696, 152840, 147656, 152896
  .long 147712, 152912, 147728, 152928, 147744, 152944, 147760, 152904
  .long 147720, 152960, 147776, 152976, 147792, 152992, 147808, 153008
  .long 147824, 152968, 147784, 153024, 147840, 153040, 147856, 153056
  .long 147872, 153072, 147888, 153032, 147848, 153088, 147904, 153104
  .long 147920, 153120, 147936, 153136, 147952, 153096, 147912, 153152
  .long 147968, 153168, 147984, 153184, 148000, 153200, 148016, 153160
  .long 147976, 153216, 148032, 153232, 148048, 153248, 148064, 153264
  .long 148080, 153224, 148040, 153280, 148096, 153296, 148112, 153312
  .long 148128, 153328, 148144, 153288, 148104, 154624, 148160, 154640
  .long 148176, 154656, 148192, 154672, 148208, 154632, 148168, 153368
  .long 148224, 153384, 148240, 153400, 148256, 155776, 148272, 155784
  .long 148232, 153432, 148288, 153448, 148304, 153464, 148320, 155808
  .long 148336, 155816, 148296, 153496, 148352, 153512, 148368, 153528
  .long 148384, 155840, 148400, 155848, 148360, 153560, 148416, 153576
  .long 148432, 153592, 148448, 155872, 148464, 155880, 148424, 153624
  .long 148480, 153640, 148496, 153656, 148512, 155904, 148528, 155912
  .long 148488, 153688, 148544, 153704, 148560, 153720, 148576, 155936
  .long 148592, 155944, 148552, 153752, 148608, 153768, 148624, 153784
  .long 148640, 155968, 148656, 155976, 148616, 153816, 148672, 153832
  .long 148688, 153848, 148704, 156000, 148720, 156008, 148680, 153880
  .long 150016, 153896, 150032, 153912, 150048, 156032, 150064, 156040
  .long 150024, 153944, 148760, 153960, 148776, 153976, 148792, 156064
  .long 151168, 156072, 151176, 154008, 148824, 154024, 148840, 154040
  .long 148856, 156096, 151200, 156104, 151208, 154072, 148888, 154088
  .long 148904, 154104, 148920, 156128, 151232, 156136, 151240, 154136
  .long 148952, 154152, 148968, 154168, 148984, 156160, 151264, 156168
  .long 151272, 154200, 149016, 154216, 149032, 154232, 149048, 156192
  .long 151296, 156200, 151304, 154264, 149080, 154280, 149096, 154296
  .long 149112, 156224, 151328, 156232, 151336, 154328, 149144, 154344
  .long 149160, 154360, 149176, 156256, 151360, 156264, 151368, 154392
  .long 149208, 154408, 149224, 154424, 149240, 156288, 151392, 156296
  .long 151400, 154456, 149272, 154472, 149288, 154488, 149304, 156320
  .long 151424, 156328, 151432, 154520, 149336, 154536, 149352, 154552
  .long 149368, 156352, 151456, 156360, 151464, 154584, 149400, 154600
  .long 149416, 154616, 149432, 156384, 151488, 156392, 151496, 154712
  .long 149464, 154728, 149480, 154744, 149496, 156448, 151520, 156456
  .long 151528, 151528, 149528, 149528, 149544, 149544, 149560, 149560
  .long 151552, 151552, 151560, 151560, 149592, 149592, 149608, 149608
  .long 149624, 149624, 151584, 151584, 151592, 151592, 149656, 149656
  .long 149672, 149672, 149688, 149688, 151616, 151616, 151624, 151624
  .long 149720, 149720, 149736, 149736, 149752, 149752, 151648, 151648
  .long 151656, 151656, 149784, 149784, 149800, 149800, 149816, 149816
  .long 151680, 151680, 151688, 151688, 149848, 149848, 149864, 149864
  .long 149880, 149880, 151712, 151712, 151720, 151720, 149912, 149912
  .long 149928, 149928, 149944, 149944, 151744, 151744, 151752, 151752
  .long 149976, 149976, 149992, 149992, 150008, 150008, 151776, 151776
  .long 151784, 151784, 150104, 150104, 150120, 150120, 150136, 150136
  .long 151840, 151840, 151848, 151848, 152064, 152064, 152080, 152080
  .long 152096, 152096, 152112, 152112, 152072, 152072, 152128, 152128
  .long 152144, 152144, 152160, 152160, 152176, 152176, 152136, 152136
  .long 152192, 152192, 152208, 152208, 152224, 152224, 152240, 152240
  .long 152200, 152200, 152256, 152256, 152272, 152272, 152288, 152288
  .long 152304, 152304, 152264, 152264, 152320, 152320, 152336, 152336
  .long 152352, 152352, 152368, 152368, 152328, 152328, 152384, 152384
  .long 152400, 152400, 152416, 152416, 152432, 152432, 152392, 152392
  .long 152448, 152448, 152464, 152464, 152480, 152480, 152496, 152496
  .long 152456, 152456, 152512, 152512, 152528, 152528, 152544, 152544
  .long 152560, 152560, 152520, 152520, 152576, 152576, 152592, 152592
  .long 152608, 152608, 152624, 152624, 152584, 152584, 152640, 152640
.size L_table, 4096
.section .rodata,"a"
.p2align 6
.amdhsa_kernel parallel_sum__linear_attn_block__dense_activation_gelu__prompt_kernel
  .amdhsa_next_free_vgpr 256
  .amdhsa_next_free_sgpr 102
  .amdhsa_accum_offset 256
  .amdhsa_group_segment_fixed_size 0
  .amdhsa_kernarg_size 88
  .amdhsa_user_sgpr_count 2
  .amdhsa_user_sgpr_kernarg_segment_ptr 1
  .amdhsa_system_sgpr_workgroup_id_x 1
.end_amdhsa_kernel
```
